```python
import torch

def _softmax(x, axis=-1):
    return torch.softmax(x, dim=axis)
def _gelu(x):
    return torch.nn.functional.gelu(x, approximate="tanh")
def _silu(x):
    return torch.nn.functional.silu(x)
def _sigmoid(x):
    return torch.sigmoid(x)
def _layernorm(x, axis=-1, eps=1e-5):
    m = x.mean(dim=axis, keepdim=True)
    v = x.var(dim=axis, keepdim=True, unbiased=False)
    return (x - m) / torch.sqrt(v + eps)
def _scatter_add(tgt, idx, src, axis=0):
    return tgt.clone().index_add_(axis, idx, src)
def _segment_sum(src, seg, n):
    out = torch.zeros((n,) + src.shape[1:], dtype=src.dtype)
    return out.index_add_(0, seg, src)
def _pad(x, pw):
    flat = tuple(v for pair in reversed(pw) for v in pair)
    return torch.nn.functional.pad(x, flat)

kernel_name = 'concat_heads__ssm_conv_s4d__softmax_full_mha__prompt'

def setup_inputs():

    _w = (lambda a: (lambda t: t.to(torch.bfloat16) if t.is_floating_point() else t)(torch.as_tensor(a)))
    def _A_setup():
        Bsz, L, D, N = 1, 2048, 448, 256
        return {
            "u": _w((lambda *s: torch.randn(*s, dtype=torch.bfloat16) * 0.05)(Bsz, L, D)),
            "log_A_real": _w((lambda *s: torch.randn(*s, dtype=torch.bfloat16) * 6.4)(D, N) * 0.5),
            "A_imag": _w((lambda *s: torch.randn(*s, dtype=torch.bfloat16) * 0.1)(D, N) * 3.14),
            "C_real": _w((lambda *s: torch.randn(*s, dtype=torch.bfloat16) * 0.4)(D, N) / N ** 0.5),
            "C_imag": _w((lambda *s: torch.randn(*s, dtype=torch.bfloat16) * 0.4)(D, N) / N ** 0.5),
            "log_dt": _w((lambda *s: torch.randn(*s, dtype=torch.bfloat16) * 0.1)(D) * 0.5 - 4.0),
            "D_skip": _w((lambda *s: torch.randn(*s, dtype=torch.bfloat16) * 0.1)(D)),
        }
    _A_in = _A_setup()

    def _B_setup():
        B, S, D = 1, 2048, 448
        return {
            "x": _w((lambda *s: torch.randn(*s, dtype=torch.bfloat16) * 0.2)(B, S, D)),
            "wqkv": _w((lambda *s: torch.randn(*s, dtype=torch.bfloat16) * 0.2)(D, 3 * D)),
            "wo": _w((lambda *s: torch.randn(*s, dtype=torch.bfloat16) * 0.05)(D, D)),
        }
    _B_in = _B_setup()

    return {
        "A_u": _A_in["u"],
        "A_log_A_real": _A_in["log_A_real"],
        "A_A_imag": _A_in["A_imag"],
        "A_C_real": _A_in["C_real"],
        "A_C_imag": _A_in["C_imag"],
        "A_log_dt": _A_in["log_dt"],
        "A_D_skip": _A_in["D_skip"],
        "B_x": _B_in["x"],
        "B_wqkv": _B_in["wqkv"],
        "B_wo": _B_in["wo"],
    }

def reference(A_u, A_log_A_real, A_A_imag, A_C_real, A_C_imag, A_log_dt, A_D_skip, B_x, B_wqkv, B_wo):
    def _A_ref(u, log_A_real, A_imag, C_real, C_imag, log_dt, D_skip):
        L = u.shape[1]
        dt = torch.exp(log_dt)
        A = -torch.exp(log_A_real) + 1j * A_imag
        C = (C_real + 1j * C_imag) * dt[:, None]
        pos = (lambda x, dt: x.to(dt))(torch.arange(L), log_dt.dtype)
        P = torch.exp((A * dt[:, None])[:, :, None] * pos[None, None, :])
        K = 2.0 * torch.einsum("dn,dnl->dl", C, P).real
        L2 = 2 * L
        u_t = (lambda x, *d: x.permute(*d))(u, 0, 2, 1)
        Kf = (lambda x, *a, **k: torch.fft.rfft(x.float(), *a, **k))(K, L2)
        Uf = (lambda x, *a, **k: torch.fft.rfft(x.float(), *a, **k))(u_t, L2)
        y = (lambda x, *a, **k: torch.fft.irfft(x, *a, **k).to(torch.bfloat16))(Uf * Kf[None, :, :], L2)[:, :, :L]
        y = (lambda x, *d: x.permute(*d))(y, 0, 2, 1)
        return y + u * D_skip[None, None, :]

    def _B_ref(x, wqkv, wo):
        B, S, D = x.shape
        H = 16; Dh = D // H
        qkv = (lambda x, *d: x.permute(*d))((x @ wqkv).reshape(B, S, 3, H, Dh), 2, 0, 3, 1, 4)
        q, k, v = qkv[0], qkv[1], qkv[2]
        scale = Dh ** -0.5
        scores = torch.einsum("bhqd,bhkd->bhqk", q, k) * scale
        p = _softmax(scores, axis=-1)
        o = torch.einsum("bhqk,bhkd->bhqd", p, v)
        return (lambda x, *d: x.permute(*d))(o, 0, 2, 1, 3).reshape(B, S, D) @ wo

    a = _A_ref(A_u, A_log_A_real, A_A_imag, A_C_real, A_C_imag, A_log_dt, A_D_skip)
    b = _B_ref(B_x, B_wqkv, B_wo)
    return torch.concatenate([a, b], axis=-1)
```

```asm
; @launch grid=(512,1,1) block=(256,1,1) lds=81920
.amdgcn_target "amdgcn-amd-amdhsa--gfx950"
.text
.globl concat_heads__ssm_conv_s4d__softmax_full_mha__prompt_kernel
.p2align 12
.p2align 8
.type concat_heads__ssm_conv_s4d__softmax_full_mha__prompt_kernel,@function
concat_heads__ssm_conv_s4d__softmax_full_mha__prompt_kernel:
    s_load_dwordx16 s[4:19], s[0:1], 0
    s_load_dwordx8 s[20:27], s[0:1], 64
    s_load_dwordx2 s[28:29], s[0:1], 96
    s_cmp_ge_u32 s2, 256
    s_cbranch_scc1 L_notA
    s_setprio 2
    v_lshrrev_b32 v2, 6, v0
    v_and_b32 v1, 63, v0
    v_readfirstlane_b32 s36, v2
    s_and_b32 s37, s2, 7
    s_lshr_b32 s38, s2, 3
    s_getpc_b64 s[60:61]
L_pc:
    v_lshrrev_b32 v8, 4, v0
    v_lshl_add_u32 v8, s38, 4, v8
    v_lshlrev_b32 v8, 7, v8
    v_min_u32 v8, L_codeend-L_pc-4, v8
    v_mov_b32 v9, s61
    v_add_co_u32 v8, vcc, s60, v8
    s_nop 1
    v_addc_co_u32 v9, vcc, 0, v9, vcc
    global_load_dword v255, v[8:9], off
    s_and_b32 s46, s2, 0x86
    s_cmp_eq_u32 s46, 0
    s_cbranch_scc1 L_idle
    s_lshl_b32 s46, s37, 4
    s_add_u32 s46, s46, s38
    s_sub_u32 s46, s46, 16
    s_sub_u32 s37, s37, 2
    s_cselect_b32 s37, 6, s37
    s_cselect_b32 s38, s46, s38
    s_lshl_b32 s39, s37, 5
    s_add_u32 s39, s39, s38
    s_lshl_b32 s46, s39, 10
    v_lshl_add_u32 v2, v0, 2, s46
    s_and_b32 s45, s36, 1
    v_lshrrev_b32 v5, 3, v1
    v_and_b32 v6, 7, v1
    v_lshrrev_b32 v7, 5, v1
    s_lshl_b32 s46, s45, 2
    v_or_b32 v7, s46, v7
    v_xor_b32 v7, v6, v7
    v_lshlrev_b32 v7, 4, v7
    v_mul_u32_u24 v3, 896, v5
    v_xor_b32 v8, 32, v7
    v_add_u32 v4, 6144, v3
    v_add_u32 v4, v4, v8
    v_add_u32 v3, v3, v7
    s_lshl_b32 s46, s38, 2
    s_add_u32 s46, s46, s36
    s_mul_i32 s46, s46, 14336
    s_lshl_b32 s47, s37, 7
    s_add_u32 s46, s46, s47
    s_lshl_b32 s47, s36, 11
    s_lshl_b32 s48, s39, 2
    s_add_u32 m0, s47, 52224
    s_waitcnt lgkmcnt(0)
    global_load_dword v12, v2, s[6:7]
    global_load_dword v13, v2, s[8:9]
    global_load_dword v14, v2, s[10:11]
    global_load_dword v15, v2, s[12:13]
    s_load_dword s42, s[14:15], s48
    s_load_dword s40, s[28:29], 0
    s_load_dword s43, s[16:17], s48
    s_mov_b32 s32, s4
    s_mov_b32 s33, s5
    s_mov_b32 s34, 1835008
    s_mov_b32 s35, 0x00020000
    buffer_load_dwordx4 v3, s[32:35], s46 offen lds
    buffer_load_dwordx4 v4, s[32:35], s46 offen offset:1024 lds
    s_setprio 0
    s_branch L_roleA
L_notA:
    s_cmp_ge_u32 s2, 512
    s_cbranch_scc1 L_exit
L_roleB:
    s_setprio 1
    v_lshrrev_b32 v2, 6, v0
    v_and_b32 v1, 63, v0
    v_readfirstlane_b32 s58, v2
    s_and_b32 s61, s2, 7
    s_bfe_u32 s31, s2, 0x30003
    s_and_b32 s40, s61, 1
    s_bfe_u32 s62, s2, 0x20006
    s_and_b32 s30, s61, 6
    s_lshl_b32 s30, s30, 1
    s_add_u32 s30, s30, s62
    s_mul_i32 s64, s40, 3
    s_add_u32 s64, s64, s62
    s_lshl_b32 s62, s62, 1
    s_mul_i32 s63, s40, 7
    s_add_u32 s63, s63, s31
    s_add_u32 s63, s63, 7
    s_cmp_eq_u32 s31, 7
    s_cselect_b32 s63, 0x100000, s63
    s_lshl_b32 s65, s63, 7
    s_mul_i32 s64, s58, 43008
    s_add_u32 s63, s65, s64
    s_lshl_b32 s61, s30, 2
    s_add_u32 s61, s61, s58
    s_mul_i32 s61, s61, 28672
    s_and_b32 s62, s2, 6
    s_bitcmp1_b32 s2, 0
    s_cselect_b32 s64, 3, 0
    s_add_u32 s62, s62, s64
    s_cmp_ge_u32 s62, 7
    s_cselect_b32 s64, 7, 0
    s_sub_u32 s62, s62, s64
    s_lshl_b32 s42, s62, 7
    s_add_u32 s42, s42, s61
    s_mul_i32 s49, s62, 172032
    s_add_u32 s49, s49, s63
    s_lshl_b32 s56, s58, 12
    s_lshl_b32 s57, s58, 11
    s_add_u32 s57, s57, 49152
    v_lshrrev_b32 v17, 3, v1
    v_and_b32 v18, 7, v1
    v_lshrrev_b32 v19, 4, v1
    v_xor_b32 v20, v18, v19
    v_lshlrev_b32 v20, 4, v20
    v_mul_u32_u24 v2, 896, v17
    v_xor_b32 v21, 64, v20
    v_add_u32 v3, 6144, v2
    v_add_u32 v3, v3, v21
    v_add_u32 v2, v2, v20
    v_add_u32 v4, 12288, v2
    v_add_u32 v5, 12288, v3
    v_and_b32 v20, 1, v19
    v_lshlrev_b32 v20, 2, v20
    v_xor_b32 v20, v18, v20
    v_lshlrev_b32 v20, 4, v20
    v_mul_u32_u24 v6, 2688, v17
    v_add_u32 v6, v6, v20
    v_add_u32 v7, 20480, v6
    s_waitcnt lgkmcnt(0)
    s_mov_b32 s4, s18
    s_mov_b32 s5, s19
    s_mov_b32 s6, 1835008
    s_mov_b32 s7, 0x00020000
    s_mov_b32 s8, s20
    s_mov_b32 s9, s21
    s_mov_b32 s10, 1204224
    s_mov_b32 s11, 0x00020000
    s_add_u32 m0, s57, 0
    s_nop 0
    buffer_load_dwordx4 v6, s[8:11], s49 offen offset:0 lds
    buffer_load_dwordx4 v7, s[8:11], s49 offen offset:1024 lds
    s_add_u32 m0, s56, 0
    s_nop 0
    buffer_load_dwordx4 v2, s[4:7], s42 offen offset:0 lds
    buffer_load_dwordx4 v3, s[4:7], s42 offen offset:1024 lds
    buffer_load_dwordx4 v4, s[4:7], s42 offen offset:2048 lds
    buffer_load_dwordx4 v5, s[4:7], s42 offen offset:3072 lds
    s_add_u32 s62, s62, 1
    s_cmp_eq_u32 s62, 7
    s_cselect_b32 s62, 0, s62
    s_lshl_b32 s43, s62, 7
    s_add_u32 s43, s43, s61
    s_mul_i32 s50, s62, 172032
    s_add_u32 s50, s50, s63
    s_load_dword s41, s[28:29], 0
    s_mov_b32 s16, s58
    s_add_u32 s62, s62, 1
    s_cmp_eq_u32 s62, 7
    s_cselect_b32 s62, 0, s62
    s_lshl_b32 s44, s62, 7
    s_add_u32 s44, s44, s61
    s_mul_i32 s51, s62, 172032
    s_add_u32 s51, s51, s63
    s_add_u32 s62, s62, 1
    s_cmp_eq_u32 s62, 7
    s_cselect_b32 s62, 0, s62
    s_lshl_b32 s45, s62, 7
    s_add_u32 s45, s45, s61
    s_mul_i32 s52, s62, 172032
    s_add_u32 s52, s52, s63
    s_add_u32 s62, s62, 1
    s_cmp_eq_u32 s62, 7
    s_cselect_b32 s62, 0, s62
    s_lshl_b32 s46, s62, 7
    s_add_u32 s46, s46, s61
    s_mul_i32 s53, s62, 172032
    s_add_u32 s53, s53, s63
    s_add_u32 s62, s62, 1
    s_cmp_eq_u32 s62, 7
    s_cselect_b32 s62, 0, s62
    s_lshl_b32 s47, s62, 7
    s_add_u32 s47, s47, s61
    s_mul_i32 s54, s62, 172032
    s_add_u32 s54, s54, s63
    s_add_u32 s62, s62, 1
    s_cmp_eq_u32 s62, 7
    s_cselect_b32 s62, 0, s62
    s_lshl_b32 s48, s62, 7
    s_add_u32 s48, s48, s61
    s_mul_i32 s55, s62, 172032
    s_add_u32 s55, s55, s63
    s_lshl_b32 s17, s40, 3
    s_add_u32 s17, s17, s31
    s_mul_i32 s59, s17, 7
    s_lshr_b32 s59, s59, 1
    s_lshl_b32 s59, s59, 4
    s_sub_u32 s65, s59, s65
    s_mov_b32 s32, s22
    s_mov_b32 s33, s23
    s_mov_b32 s34, 401408
    s_mov_b32 s35, 0x00020000
    s_mov_b32 s36, s24
    s_mov_b32 s37, s25
    s_mov_b32 s38, 3670016
    s_mov_b32 s39, 0x00020000
    v_and_b32 v17, 31, v1
    v_lshrrev_b32 v18, 5, v1
    v_bfe_u32 v19, v17, 1, 3
    v_xor_b32 v19, v19, v18
    v_lshlrev_b32 v19, 4, v19
    v_lshl_add_u32 v20, v17, 7, s56
    v_xor_b32 v21, 0, v19
    v_add_u32 v8, v20, v21
    v_xor_b32 v21, 32, v19
    v_add_u32 v9, v20, v21
    v_xor_b32 v21, 64, v19
    v_add_u32 v10, v20, v21
    v_xor_b32 v21, 96, v19
    v_add_u32 v11, v20, v21
    v_bfe_u32 v19, v1, 2, 2
    v_lshl_add_u32 v20, v18, 3, v19
    v_and_b32 v21, 3, v1
    v_bfe_u32 v22, v1, 4, 1
    v_lshl_add_u32 v21, v22, 2, v21
    v_and_b32 v22, 1, v1
    v_bfe_u32 v23, v1, 1, 1
    v_lshl_add_u32 v22, v22, 1, v23
    v_and_b32 v23, 4, v21
    v_add_u32 v22, v22, v23
    v_lshlrev_b32 v15, 6, v20
    v_lshl_add_u32 v15, v22, 3, v15
    s_cmp_eq_u32 s40, 1
    s_cselect_b64 vcc, -1, 0
    v_cndmask_b32 v21, v22, v21, vcc
    v_lshrrev_b32 v19, 1, v19
    v_lshlrev_b32 v19, 6, v19
    v_lshlrev_b32 v21, 3, v21
    v_lshlrev_b32 v20, 7, v20
    v_add_u32 v20, 49152, v20
    v_xor_b32 v12, v21, v19
    v_xor_b32 v13, 64, v12
    v_add_u32 v12, v12, v20
    v_add_u32 v13, v13, v20
    v_lshrrev_b32 v19, 2, v1
    v_and_b32 v20, 3, v1
    v_mul_u32_u24 v14, 2688, v19
    v_lshl_add_u32 v14, v20, 4, v14
    v_and_b32 v19, 0x13, v17
    v_bfe_u32 v20, v17, 2, 1
    v_lshl_or_b32 v19, v20, 3, v19
    v_bfe_u32 v20, v17, 3, 1
    v_lshl_or_b32 v19, v20, 2, v19
    v_lshlrev_b32 v19, 4, v19
    v_lshl_add_u32 v19, v18, 9, v19
    v_mul_u32_u24 v20, 7168, v18
    v_lshl_add_u32 v20, v17, 4, v20
    v_cndmask_b32 v16, v19, v20, vcc
    s_lshl_b32 s62, s31, 12
    s_add_u32 s62, s62, 589824
    s_lshl_b32 s63, s31, 10
    s_add_u32 s63, s63, 618496
    s_lshl_b32 s61, s30, 2
    s_add_u32 s61, s61, s16
    s_mul_i32 s61, s61, 90240
    s_lshl_b32 s66, s17, 11
    s_add_u32 s66, s66, s61
    s_add_u32 s66, s66, 647168
    s_cmp_eq_u32 s40, 1
    s_cselect_b32 s62, s63, s62
    s_add_u32 s61, s61, s62
    s_cmp_eq_u32 s31, 7
    s_cselect_b32 s61, 10485760, s61
    s_add_u32 s62, s61, 14336
    s_lshl_b32 s63, s16, 10
    s_lshl_b32 s18, s59, 5
    v_lshlrev_b32 v250, 4, v1
    v_add_u32 v19, s18, v250
    s_and_b32 s18, s2, 63
    s_lshl_b32 s18, s18, 7
    s_bfe_u32 s19, s2, 0x20006
    s_lshl_b32 s19, s19, 15
    s_add_u32 s18, s18, s19
    s_add_u32 s18, s18, 135168
    v_mov_b32 v204, s18
    v_and_b32 v203, 1, v1
    v_mul_u32_u24 v203, 14336, v203
    v_add_u32 v203, v204, v203
    v_mov_b32 v208, 0x3f803f80
    v_mov_b32 v212, 0
    v_mov_b32 v209, 0x3f803f80
    v_mov_b32 v213, 0
    v_mov_b32 v210, 0x3f803f80
    v_mov_b32 v214, 0
    v_mov_b32 v211, 0x3f803f80
    v_mov_b32 v215, 0
    s_mul_i32 s18, s17, 448
    s_add_u32 s18, s18, 618496
    v_bfe_u32 v205, v17, 3, 1
    v_and_b32 v206, 3, v17
    v_lshl_add_u32 v205, v205, 2, v206
    v_cmp_gt_u32 vcc, 16, v17
    v_cmp_ne_u32 s[26:27], 7, v205
    v_bfe_u32 v206, v17, 2, 1
    v_mad_u32_u24 v205, v206, 7, v205
    v_lshrrev_b32 v206, 4, v17
    v_mad_u32_u24 v205, v206, 14, v205
    v_mul_u32_u24 v251, 7168, v18
    v_lshl_add_u32 v251, v205, 4, v251
    v_add_u32 v251, s18, v251
    v_mov_b32 v206, 10485760
    v_cndmask_b32 v204, v206, v204, vcc
    v_mov_b32 v22, 90240
    v_cndmask_b32 v251, v204, v251, s[26:27]
    v_cndmask_b32 v22, 0, v22, s[26:27]
    s_lshl_b32 s18, s16, 1
    v_mad_u32_u24 v20, v22, s18, v251
    s_mul_i32 s18, s17, 28
    s_lshr_b32 s19, s18, 6
    s_add_u32 s18, s18, 27
    s_lshr_b32 s18, s18, 6
    s_sub_u32 s18, s18, s19
    s_add_u32 s19, s19, 32
    v_and_b32 v207, s18, v1
    v_and_b32 v205, 2, v1
    v_lshl_add_u32 v207, v205, 2, v207
    v_add_lshl_u32 v207, v207, s19, 7
    s_and_b32 s67, s30, 12
    s_max_u32 s67, s67, 2
    s_lshl_b32 s18, s67, 11
    v_and_b32 v205, 60, v1
    v_lshl_add_u32 v248, v205, 9, v207
    v_and_b32 v205, 12, v1
    v_lshl_add_u32 v249, v205, 9, v207
    v_add_u32 v249, s18, v249
    s_lshr_b32 s18, s16, 1
    v_lshl_add_u32 v207, s18, 11, v207
    s_lshl_b32 s18, s30, 4
    s_add_u32 s18, s18, s17
    s_lshl_b32 s60, s18, 7
    s_add_u32 s18, s60, 4096
    s_cmp_eq_u32 s16, 0
    s_cselect_b32 s18, s18, 10485760
    v_lshl_add_u32 v23, v17, 2, s18
    s_and_b32 s18, s17, 1
    v_mov_b32 v200, 0x3e8b97f6
    v_cmp_gt_u32 vcc, s18, v18
    v_cmp_lt_u32 s[26:27], s18, v18
    v_add_u32 v255, s56, v250
    v_add_u32 v252, 4096, v255
    v_and_b32 v252, 0x3fff, v252
    v_add_u32 v253, 8192, v255
    v_and_b32 v253, 0x3fff, v253
    v_add_u32 v254, 12288, v255
    v_and_b32 v254, 0x3fff, v254
    v_cndmask_b32 v201, v200, 0, vcc
    v_cndmask_b32 v202, v200, 0, s[26:27]
    v_lshrrev_b32 v21, 3, v1
    v_and_b32 v205, 7, v1
    v_bfe_u32 v206, v1, 4, 1
    v_lshlrev_b32 v206, 2, v206
    v_xor_b32 v205, v205, v206
    v_mul_u32_u24 v21, 896, v21
    v_lshl_add_u32 v21, v205, 4, v21
    s_lshl_b32 s18, s31, 7
    s_mul_i32 s19, s16, 7168
    s_add_u32 s18, s18, s19
    v_add_u32 v21, s18, v21
    s_mov_b32 s34, 28672
    s_cmp_lt_u32 s30, 2
    s_cselect_b32 s19, 10485760, 0
    s_mul_i32 s18, s16, 180480
    s_add_u32 s18, s18, 589824
    s_cmp_eq_u32 s16, 1
    s_cbranch_scc1 L_stub_B2
    s_cmp_eq_u32 s16, 2
    s_cbranch_scc1 L_stub_B3
    s_cmp_eq_u32 s16, 3
    s_cbranch_scc1 L_stub_B4
L_backB:
    s_cmp_eq_u32 s40, 1
    s_cbranch_scc1 L_pg_B1V
    s_branch L_pg_B1K
L_exit:
    s_endpgm
L_roleA:
    s_lshl_b32 s50, s39, 7
    s_lshr_b32 s44, s36, 1
    v_mov_b32 v16, 0
    v_mov_b32 v17, 0
    v_mov_b32 v18, 0
    v_mov_b32 v19, 0
    v_and_b32 v8, 127, v0
    v_min_u32 v8, 89, v8
    v_lshlrev_b32 v8, 4, v8
    s_mul_i32 s46, s44, 7584
    v_add_u32 v8, s46, v8
    ds_write_b128 v8, v[16:19] offset:36864
    v_bfe_u32 v8, v0, 2, 3
    v_mul_u32_u24 v8, 4160, v8
    v_and_b32 v7, 3, v0
    v_lshl_add_u32 v8, v7, 4, v8
    ds_write_b128 v8, v[16:19] offset:0
    s_lshl_b32 s46, s36, 1
    v_lshrrev_b32 v7, 5, v1
    v_add_u32 v7, s46, v7
    v_xor_b32 v7, v7, v6
    v_lshlrev_b32 v7, 4, v7
    v_lshl_add_u32 v7, v6, 9, v7
    v_and_b32 v8, 3, v5
    v_lshl_add_u32 v9, v8, 2, v7
    v_lshlrev_b32 v10, 13, v5
    v_lshl_add_u32 v10, v6, 4, v10
    s_lshl_b32 s46, s37, 2
    s_add_u32 s46, s46, s36
    s_lshl_b32 s46, s46, 16
    s_lshl_b32 s47, s38, 8
    s_add_u32 s49, s46, s47
    s_add_u32 s51, s49, 6422528
    s_mov_b32 s52, 0x3fb8aa3b
    s_mov_b32 s53, 0x32a57060
    s_mov_b32 s54, 0x3f317218
    s_mov_b32 s55, 0x3e22f983
    s_mov_b32 s56, 0x41000000
    s_mov_b32 s57, s56
    s_mov_b32 s58, 0x43800000
    s_mov_b32 s59, s58
    s_lshl_b32 s46, s37, 12
    s_add_u32 s46, s46, 69632
    v_and_b32 v6, 31, v1
    v_lshl_add_u32 v6, v6, 7, s46
    v_lshrrev_b32 v18, 5, v1
    v_mov_b32 v19, 0x3c00
    v_and_b32 v16, 15, v1
    v_bfe_u32 v17, v1, 4, 1
    v_and_b32 v28, 1, v16
    v_lshlrev_b32 v28, 4, v28
    v_lshlrev_b32 v28, v28, v19
    v_cmp_eq_u32 vcc, v17, v18
    v_lshrrev_b32 v29, 1, v16
    s_nop 0
    v_cndmask_b32 v28, 0, v28, vcc
    v_cmp_eq_u32 s[60:61], 0, v29
    v_cmp_eq_u32 s[62:63], 1, v29
    s_nop 0
    v_cndmask_b32 v48, 0, v28, s[60:61]
    v_cmp_eq_u32 s[60:61], 2, v29
    v_cndmask_b32 v49, 0, v28, s[62:63]
    v_cmp_eq_u32 s[62:63], 3, v29
    v_cndmask_b32 v50, 0, v28, s[60:61]
    v_cmp_eq_u32 s[60:61], 4, v29
    v_cndmask_b32 v51, 0, v28, s[62:63]
    v_cmp_eq_u32 s[62:63], 5, v29
    v_cndmask_b32 v52, 0, v28, s[60:61]
    v_cmp_eq_u32 s[60:61], 6, v29
    v_cndmask_b32 v53, 0, v28, s[62:63]
    v_cmp_eq_u32 s[62:63], 7, v29
    v_cndmask_b32 v54, 0, v28, s[60:61]
    s_nop 0
    v_cndmask_b32 v55, 0, v28, s[62:63]
    v_bfe_u32 v17, v1, 2, 1
    v_mov_b32 v16, 0x75316420
    v_mov_b32 v30, 0x85111400
    v_cmp_eq_u32 vcc, 1, v17
    v_bfe_u32 v28, v1, 3, 1
    v_and_b32 v29, 3, v1
    v_cndmask_b32 v16, v16, v30, vcc
    v_and_b32 v31, 16, v1
    v_cmp_eq_u32 vcc, 16, v31
    v_mov_b32 v30, 0xffedcb9a
    v_lshl_add_u32 v28, v28, 2, v29
    v_cndmask_b32 v16, v16, v30, vcc
    v_lshlrev_b32 v28, 2, v28
    v_bfe_u32 v16, v16, v28, 4
    v_and_b32 v28, 1, v16
    v_lshlrev_b32 v28, 4, v28
    v_lshlrev_b32 v28, v28, v19
    v_cmp_eq_u32 vcc, v17, v18
    v_lshrrev_b32 v29, 1, v16
    s_nop 0
    v_cndmask_b32 v28, 0, v28, vcc
    v_cmp_eq_u32 s[60:61], 0, v29
    v_cmp_eq_u32 s[62:63], 1, v29
    s_nop 0
    v_cndmask_b32 v56, 0, v28, s[60:61]
    v_cmp_eq_u32 s[60:61], 2, v29
    v_cndmask_b32 v57, 0, v28, s[62:63]
    v_cmp_eq_u32 s[62:63], 3, v29
    v_cndmask_b32 v58, 0, v28, s[60:61]
    v_cmp_eq_u32 s[60:61], 4, v29
    v_cndmask_b32 v59, 0, v28, s[62:63]
    v_cmp_eq_u32 s[62:63], 5, v29
    v_cndmask_b32 v60, 0, v28, s[60:61]
    v_cmp_eq_u32 s[60:61], 6, v29
    v_cndmask_b32 v61, 0, v28, s[62:63]
    v_cmp_eq_u32 s[62:63], 7, v29
    v_cndmask_b32 v62, 0, v28, s[60:61]
    s_nop 0
    v_cndmask_b32 v63, 0, v28, s[62:63]
    s_setreg_imm32_b32 hwreg(HW_REG_MODE, 9, 1), 0
    s_cmp_eq_u32 s36, 1
    s_cbranch_scc1 L_stub_A2
    s_cmp_eq_u32 s36, 2
    s_cbranch_scc1 L_stub_A3
    s_cmp_eq_u32 s36, 3
    s_cbranch_scc1 L_stub_B5
L_backA:
    s_branch L_pg_A1
.p2align 12
L_stub_A1:
L_pg_A1:
    s_waitcnt lgkmcnt(0)
    s_add_u32 s40, s40, 0x9e3779b9
    s_mov_b32 s4, s28
    s_mov_b32 s5, s29
    s_mov_b32 s6, 10485760
    s_mov_b32 s7, 0x00020000
    s_mov_b32 s8, s24
    s_mov_b32 s9, s25
    s_mov_b32 s10, 3670016
    s_mov_b32 s11, 0x00020000
    s_lshl_b32 s47, s44, 4
    s_lshr_b32 s42, s42, s47
    s_lshl_b32 s42, s42, 16
    s_lshr_b32 s43, s43, s47
    s_lshl_b32 s43, s43, 16
    v_mov_b32 v28, s42
    v_mul_f32 v29, s52, v28
    v_fma_f32 v30, v28, s52, -v29
    v_exp_f32 v29, v29
    v_fma_f32 v30, v28, s53, v30
    v_mul_f32 v30, s54, v30
    v_fma_f32 v29, v29, v30, v29
    v_cvt_pk_bf16_f32 v29, v29, v29
    v_lshlrev_b32 v11, 16, v29
    v_mul_f32 v4, 0xbfb8aa3b, v11
    v_mul_f32 v5, s55, v11
    s_mov_b32 s56, 0x41800000
    s_mov_b32 s57, 0x07060302
    s_waitcnt vmcnt(2)
    s_setprio 2
    v_and_b32 v28, 0x7fff7fff, v14
    v_and_b32 v29, 0x7fff7fff, v15
    v_pk_max_u16 v28, v28, v29
    v_lshlrev_b32 v29, 16, v28
    v_max_u32 v28, v28, v29
    v_lshlrev_b32 v16, 16, v12
    s_nop 0
    v_max_u32_dpp v28, v28, v28 row_shr:1 row_mask:0xf bank_mask:0xf
    v_lshlrev_b32 v17, 16, v13
    v_lshlrev_b32 v18, 16, v14
    v_lshlrev_b32 v19, 16, v15
    v_max_u32_dpp v28, v28, v28 row_shr:2 row_mask:0xf bank_mask:0xf
    v_mul_f32 v29, s52, v16
    v_fma_f32 v30, v16, s52, -v29
    v_max_u32_dpp v28, v28, v28 row_shr:4 row_mask:0xf bank_mask:0xf
    v_exp_f32 v29, v29
    v_fma_f32 v30, v16, s53, v30
    v_mul_f32 v30, s54, v30
    v_max_u32_dpp v28, v28, v28 row_shr:8 row_mask:0xf bank_mask:0xf
    v_fma_f32 v29, v29, v30, v29
    v_cvt_pk_bf16_f32 v29, v29, v29
    v_lshlrev_b32 v16, 16, v29
    v_max_u32_dpp v28, v28, v28 row_bcast:15 row_mask:0xf bank_mask:0xf
    v_mul_f32 v17, v17, v5
    v_mul_f32 v16, v16, v4
    v_max_u32_dpp v28, v28, v28 row_bcast:31 row_mask:0xf bank_mask:0xf
    s_nop 0
    v_readlane_b32 s60, v28, 63
    v_fract_f32 v66, v17
    v_exp_f32 v92, v16
    v_cos_f32 v65, v66
    v_sin_f32 v66, v66
    v_mul_f32 v65, v65, v92
    v_mul_f32 v66, v66, v92
    s_lshr_b32 s60, s60, 23
    s_max_u32 s60, s60, 9
    s_sub_u32 s61, s60, 8
    s_lshl_b32 s61, s61, 23
    s_sub_u32 s60, 262, s60
    s_lshl_b32 s60, s60, 23
    v_mul_f32 v75, s56, v17
    v_mul_f32 v92, s56, v16
    v_fract_f32 v75, v75
    v_exp_f32 v92, v92
    v_cos_f32 v74, v75
    v_sin_f32 v75, v75
    v_mul_f32 v74, v74, v92
    v_mul_f32 v75, v75, v92
    v_mul_f32 v84, s58, v17
    v_mul_f32 v92, s58, v16
    v_fract_f32 v84, v84
    v_exp_f32 v92, v92
    v_cos_f32 v83, v84
    v_sin_f32 v84, v84
    v_mul_f32 v83, v83, v92
    v_mul_f32 v84, v84, v92
    s_waitcnt vmcnt(0)
    s_barrier
    ds_read_b32 v20, v9 offset:52224
    ds_read_b32 v21, v9 offset:52352
    ds_read_b32 v22, v9 offset:52480
    ds_read_b32 v23, v9 offset:52608
    ds_read_b32 v24, v9 offset:56320
    ds_read_b32 v25, v9 offset:56448
    ds_read_b32 v26, v9 offset:56576
    ds_read_b32 v27, v9 offset:56704
    v_mul_f32 v67, v65, v65
    v_mul_f32 v68, v65, v66 mul:2
    v_fma_f32 v67, -v66, v66, v67
    v_mul_f32 v69, v67, v67
    v_mul_f32 v70, v67, v68 mul:2
    v_fma_f32 v69, -v68, v68, v69
    v_mul_f32 v71, v69, v69
    v_mul_f32 v73, v69, v70 mul:2
    v_fma_f32 v71, -v70, v70, v71
    v_mul_f32 v76, v74, v74
    v_mul_f32 v77, v74, v75 mul:2
    v_fma_f32 v76, -v75, v75, v76
    v_mul_f32 v78, v76, v76
    v_mul_f32 v79, v76, v77 mul:2
    v_fma_f32 v78, -v77, v77, v78
    v_mul_f32 v81, v78, v78
    v_mul_f32 v82, v78, v79 mul:2
    v_fma_f32 v81, -v79, v79, v81
    v_mul_f32 v85, v83, v83
    v_mul_f32 v86, v83, v84 mul:2
    v_fma_f32 v85, -v84, v84, v85
    s_waitcnt lgkmcnt(0)
    buffer_store_dwordx4 v[20:23], v10, s[4:7], s51 offen sc1
    buffer_store_dwordx4 v[24:27], v10, s[4:7], s51 offen offset:128 sc1
    v_mul_f32 v18, s60, v18
    v_mul_f32 v19, s60, v19
    v_mul_f32 v87, v18, v69
    v_mul_f32 v89, v18, v70
    v_fma_f32 v87, -v19, v70, v87
    v_fmac_f32 v89, v19, v69
    v_mul_f32 v90, v18, v71
    v_mul_f32 v91, v18, v73
    v_fma_f32 v90, -v19, v73, v90
    v_fmac_f32 v91, v19, v71
    v_cvt_pk_f16_f32 v240, v65, v66
    v_cvt_pk_f16_f32 v242, v67, v68
    v_cvt_pk_f16_f32 v244, v74, v75
    v_cvt_pk_f16_f32 v246, v76, v77
    v_cvt_pk_f16_f32 v248, v78, v79
    v_cvt_pk_f16_f32 v250, v85, v86
    v_cvt_pk_f16_f32 v94, v81, v82
    v_cvt_pk_f16_f32 v95, v83, v84
    v_mov_b32 v241, v240
    v_mov_b32 v243, v242
    v_mov_b32 v245, v244
    v_mov_b32 v247, v246
    v_mov_b32 v249, v248
    v_mov_b32 v251, v250
    v_cvt_pk_f16_f32 v64, 1.0, v71
    v_cvt_pk_f16_f32 v72, 0, v73
    v_cvt_pk_f16_f32 v80, v18, v87
    v_cvt_pk_f16_f32 v88, v19, v89
    v_cvt_pk_f16_f32 v252, v18, v90
    v_cvt_pk_f16_f32 v254, v19, v91
    v_pk_mul_f16 v96, v64, v94 op_sel:[0,0] op_sel_hi:[1,0]
    v_pk_mul_f16 v104, v64, v94 op_sel:[0,1] op_sel_hi:[1,1]
    v_pk_fma_f16 v96, v72, v94, v96 op_sel:[0,1,0] op_sel_hi:[1,1,1] neg_lo:[1,0,0] neg_hi:[1,0,0]
    v_pk_fma_f16 v104, v72, v94, v104 op_sel:[0,0,0] op_sel_hi:[1,0,1]
    v_pk_mul_f16 v112, v80, v95 op_sel:[0,0] op_sel_hi:[1,0]
    v_pk_mul_f16 v120, v80, v95 op_sel:[0,1] op_sel_hi:[1,1]
    v_pk_fma_f16 v112, v88, v95, v112 op_sel:[0,1,0] op_sel_hi:[1,1,1] neg_lo:[1,0,0] neg_hi:[1,0,0]
    v_pk_fma_f16 v120, v88, v95, v120 op_sel:[0,0,0] op_sel_hi:[1,0,1]
    v_pk_mul_f16 v253, v252, v95 op_sel:[0,0] op_sel_hi:[1,0]
    v_pk_mul_f16 v255, v252, v95 op_sel:[0,1] op_sel_hi:[1,1]
    v_pk_fma_f16 v253, v254, v95, v253 op_sel:[0,1,0] op_sel_hi:[1,1,1] neg_lo:[1,0,0] neg_hi:[1,0,0]
    v_pk_fma_f16 v255, v254, v95, v255 op_sel:[0,0,0] op_sel_hi:[1,0,1]
    v_permlane32_swap_b32 v240, v241
    v_permlane32_swap_b32 v242, v243
    v_permlane32_swap_b32 v244, v245
    v_permlane32_swap_b32 v246, v247
    v_permlane32_swap_b32 v248, v249
    v_permlane32_swap_b32 v250, v251
    v_permlane32_swap_b32 v64, v96
    v_permlane32_swap_b32 v72, v104
    v_permlane32_swap_b32 v80, v112
    v_permlane32_swap_b32 v88, v120
    v_permlane32_swap_b32 v252, v253
    v_permlane32_swap_b32 v254, v255
.p2align 3
    v_pk_mul_f16 v65, v64, v244 op_sel:[0,0] op_sel_hi:[1,0]
    v_pk_mul_f16 v73, v64, v244 op_sel:[0,1] op_sel_hi:[1,1]
    v_pk_fma_f16 v65, v72, v244, v65 op_sel:[0,1,0] op_sel_hi:[1,1,1] neg_lo:[1,0,0] neg_hi:[1,0,0]
    v_pk_fma_f16 v73, v72, v244, v73 op_sel:[0,0,0] op_sel_hi:[1,0,1]
    v_pk_mul_f16 v66, v64, v246 op_sel:[0,0] op_sel_hi:[1,0]
    v_pk_mul_f16 v74, v64, v246 op_sel:[0,1] op_sel_hi:[1,1]
    v_pk_fma_f16 v66, v72, v246, v66 op_sel:[0,1,0] op_sel_hi:[1,1,1] neg_lo:[1,0,0] neg_hi:[1,0,0]
    v_pk_fma_f16 v74, v72, v246, v74 op_sel:[0,0,0] op_sel_hi:[1,0,1]
    v_pk_mul_f16 v67, v65, v246 op_sel:[0,0] op_sel_hi:[1,0]
    v_pk_mul_f16 v75, v65, v246 op_sel:[0,1] op_sel_hi:[1,1]
    v_pk_fma_f16 v67, v73, v246, v67 op_sel:[0,1,0] op_sel_hi:[1,1,1] neg_lo:[1,0,0] neg_hi:[1,0,0]
    v_pk_fma_f16 v75, v73, v246, v75 op_sel:[0,0,0] op_sel_hi:[1,0,1]
    v_pk_mul_f16 v68, v64, v248 op_sel:[0,0] op_sel_hi:[1,0]
    v_pk_mul_f16 v76, v64, v248 op_sel:[0,1] op_sel_hi:[1,1]
    v_mfma_f32_32x32x16_f16 v[128:143], v[64:67], v[48:51], 0
    v_pk_fma_f16 v68, v72, v248, v68 op_sel:[0,1,0] op_sel_hi:[1,1,1] neg_lo:[1,0,0] neg_hi:[1,0,0]
    v_pk_fma_f16 v76, v72, v248, v76 op_sel:[0,0,0] op_sel_hi:[1,0,1]
    v_pk_mul_f16 v69, v65, v248 op_sel:[0,0] op_sel_hi:[1,0]
    v_pk_mul_f16 v77, v65, v248 op_sel:[0,1] op_sel_hi:[1,1]
    v_pk_fma_f16 v69, v73, v248, v69 op_sel:[0,1,0] op_sel_hi:[1,1,1] neg_lo:[1,0,0] neg_hi:[1,0,0]
    v_pk_fma_f16 v77, v73, v248, v77 op_sel:[0,0,0] op_sel_hi:[1,0,1]
    v_mfma_f32_32x32x16_f16 v[144:159], v[72:75], v[48:51], 0
    v_pk_mul_f16 v70, v66, v248 op_sel:[0,0] op_sel_hi:[1,0]
    v_pk_mul_f16 v78, v66, v248 op_sel:[0,1] op_sel_hi:[1,1]
    v_pk_fma_f16 v70, v74, v248, v70 op_sel:[0,1,0] op_sel_hi:[1,1,1] neg_lo:[1,0,0] neg_hi:[1,0,0]
    v_pk_fma_f16 v78, v74, v248, v78 op_sel:[0,0,0] op_sel_hi:[1,0,1]
    v_pk_mul_f16 v71, v67, v248 op_sel:[0,0] op_sel_hi:[1,0]
    v_pk_mul_f16 v79, v67, v248 op_sel:[0,1] op_sel_hi:[1,1]
    v_pk_fma_f16 v71, v75, v248, v71 op_sel:[0,1,0] op_sel_hi:[1,1,1] neg_lo:[1,0,0] neg_hi:[1,0,0]
    v_pk_fma_f16 v79, v75, v248, v79 op_sel:[0,0,0] op_sel_hi:[1,0,1]
    v_pk_mul_f16 v81, v80, v240 op_sel:[0,0] op_sel_hi:[1,0]
    v_pk_mul_f16 v89, v80, v240 op_sel:[0,1] op_sel_hi:[1,1]
    v_mfma_f32_32x32x16_f16 v[128:143], v[68:71], v[52:55], v[128:143]
    v_pk_fma_f16 v81, v88, v240, v81 op_sel:[0,1,0] op_sel_hi:[1,1,1] neg_lo:[1,0,0] neg_hi:[1,0,0]
    v_pk_fma_f16 v89, v88, v240, v89 op_sel:[0,0,0] op_sel_hi:[1,0,1]
    v_pk_mul_f16 v82, v80, v242 op_sel:[0,0] op_sel_hi:[1,0]
    v_pk_mul_f16 v90, v80, v242 op_sel:[0,1] op_sel_hi:[1,1]
    v_pk_fma_f16 v82, v88, v242, v82 op_sel:[0,1,0] op_sel_hi:[1,1,1] neg_lo:[1,0,0] neg_hi:[1,0,0]
    v_pk_fma_f16 v90, v88, v242, v90 op_sel:[0,0,0] op_sel_hi:[1,0,1]
    v_mfma_f32_32x32x16_f16 v[144:159], v[76:79], v[52:55], v[144:159]
    v_pk_mul_f16 v83, v81, v242 op_sel:[0,0] op_sel_hi:[1,0]
    v_pk_mul_f16 v91, v81, v242 op_sel:[0,1] op_sel_hi:[1,1]
    v_pk_fma_f16 v83, v89, v242, v83 op_sel:[0,1,0] op_sel_hi:[1,1,1] neg_lo:[1,0,0] neg_hi:[1,0,0]
    v_pk_fma_f16 v91, v89, v242, v91 op_sel:[0,0,0] op_sel_hi:[1,0,1]
    v_pk_mul_f16 v84, v80, v250 op_sel:[0,0] op_sel_hi:[1,0]
    v_pk_mul_f16 v92, v80, v250 op_sel:[0,1] op_sel_hi:[1,1]
    v_mfma_f32_32x32x16_f16 v[160:175], v[80:83], v[56:59], 0
    v_pk_fma_f16 v84, v88, v250, v84 op_sel:[0,1,0] op_sel_hi:[1,1,1] neg_lo:[1,0,0] neg_hi:[1,0,0]
    v_pk_fma_f16 v92, v88, v250, v92 op_sel:[0,0,0] op_sel_hi:[1,0,1]
    v_pk_mul_f16 v85, v252, v250 op_sel:[0,0] op_sel_hi:[1,0]
    v_pk_mul_f16 v93, v252, v250 op_sel:[0,1] op_sel_hi:[1,1]
    v_pk_fma_f16 v85, v254, v250, v85 op_sel:[0,1,0] op_sel_hi:[1,1,1] neg_lo:[1,0,0] neg_hi:[1,0,0]
    v_pk_fma_f16 v93, v254, v250, v93 op_sel:[0,0,0] op_sel_hi:[1,0,1]
    v_mfma_f32_32x32x16_f16 v[176:191], v[88:91], v[56:59], 0
    v_perm_b32 v84, v84, v252, s57
    v_perm_b32 v92, v92, v254, s57
    v_pk_mul_f16 v86, v85, v250 op_sel:[0,0] op_sel_hi:[1,0]
    v_pk_mul_f16 v94, v85, v250 op_sel:[0,1] op_sel_hi:[1,1]
    v_pk_fma_f16 v86, v93, v250, v86 op_sel:[0,1,0] op_sel_hi:[1,1,1] neg_lo:[1,0,0] neg_hi:[1,0,0]
    v_pk_fma_f16 v94, v93, v250, v94 op_sel:[0,0,0] op_sel_hi:[1,0,1]
    v_pk_mul_f16 v87, v86, v250 op_sel:[0,0] op_sel_hi:[1,0]
    v_pk_mul_f16 v95, v86, v250 op_sel:[0,1] op_sel_hi:[1,1]
    v_pk_fma_f16 v87, v94, v250, v87 op_sel:[0,1,0] op_sel_hi:[1,1,1] neg_lo:[1,0,0] neg_hi:[1,0,0]
    v_pk_fma_f16 v95, v94, v250, v95 op_sel:[0,0,0] op_sel_hi:[1,0,1]
    v_cvt_pk_f16_f32 v192, v128, v129
    v_cvt_pk_f16_f32 v193, v130, v131
    v_mfma_f32_32x32x16_f16 v[160:175], v[84:87], v[60:63], v[160:175]
    v_cvt_pk_f16_f32 v194, v132, v133
    v_cvt_pk_f16_f32 v195, v134, v135
    v_cvt_pk_f16_f32 v196, v136, v137
    v_cvt_pk_f16_f32 v197, v138, v139
    v_cvt_pk_f16_f32 v198, v140, v141
    v_cvt_pk_f16_f32 v199, v142, v143
    v_mfma_f32_32x32x16_f16 v[176:191], v[92:95], v[60:63], v[176:191]
    v_cvt_pk_f16_f32 v200, v144, v145
    v_cvt_pk_f16_f32 v201, v146, v147
    v_cvt_pk_f16_f32 v202, v148, v149
    v_cvt_pk_f16_f32 v203, v150, v151
    v_cvt_pk_f16_f32 v204, v152, v153
    v_cvt_pk_f16_f32 v205, v154, v155
    v_cvt_pk_f16_f32 v206, v156, v157
    v_cvt_pk_f16_f32 v207, v158, v159
    v_pk_mul_f16 v97, v96, v245 op_sel:[0,0] op_sel_hi:[1,0]
    v_pk_mul_f16 v105, v96, v245 op_sel:[0,1] op_sel_hi:[1,1]
    v_pk_fma_f16 v97, v104, v245, v97 op_sel:[0,1,0] op_sel_hi:[1,1,1] neg_lo:[1,0,0] neg_hi:[1,0,0]
    v_pk_fma_f16 v105, v104, v245, v105 op_sel:[0,0,0] op_sel_hi:[1,0,1]
    v_pk_mul_f16 v98, v96, v247 op_sel:[0,0] op_sel_hi:[1,0]
    v_pk_mul_f16 v106, v96, v247 op_sel:[0,1] op_sel_hi:[1,1]
    v_pk_fma_f16 v98, v104, v247, v98 op_sel:[0,1,0] op_sel_hi:[1,1,1] neg_lo:[1,0,0] neg_hi:[1,0,0]
    v_pk_fma_f16 v106, v104, v247, v106 op_sel:[0,0,0] op_sel_hi:[1,0,1]
    v_pk_mul_f16 v99, v97, v247 op_sel:[0,0] op_sel_hi:[1,0]
    v_pk_mul_f16 v107, v97, v247 op_sel:[0,1] op_sel_hi:[1,1]
    v_pk_fma_f16 v99, v105, v247, v99 op_sel:[0,1,0] op_sel_hi:[1,1,1] neg_lo:[1,0,0] neg_hi:[1,0,0]
    v_pk_fma_f16 v107, v105, v247, v107 op_sel:[0,0,0] op_sel_hi:[1,0,1]
    v_pk_mul_f16 v100, v96, v249 op_sel:[0,0] op_sel_hi:[1,0]
    v_pk_mul_f16 v108, v96, v249 op_sel:[0,1] op_sel_hi:[1,1]
    v_mfma_f32_32x32x16_f16 v[128:143], v[96:99], v[48:51], 0
    v_pk_fma_f16 v100, v104, v249, v100 op_sel:[0,1,0] op_sel_hi:[1,1,1] neg_lo:[1,0,0] neg_hi:[1,0,0]
    v_pk_fma_f16 v108, v104, v249, v108 op_sel:[0,0,0] op_sel_hi:[1,0,1]
    v_pk_mul_f16 v101, v97, v249 op_sel:[0,0] op_sel_hi:[1,0]
    v_pk_mul_f16 v109, v97, v249 op_sel:[0,1] op_sel_hi:[1,1]
    v_pk_fma_f16 v101, v105, v249, v101 op_sel:[0,1,0] op_sel_hi:[1,1,1] neg_lo:[1,0,0] neg_hi:[1,0,0]
    v_pk_fma_f16 v109, v105, v249, v109 op_sel:[0,0,0] op_sel_hi:[1,0,1]
    v_mfma_f32_32x32x16_f16 v[144:159], v[104:107], v[48:51], 0
    v_pk_mul_f16 v102, v98, v249 op_sel:[0,0] op_sel_hi:[1,0]
    v_pk_mul_f16 v110, v98, v249 op_sel:[0,1] op_sel_hi:[1,1]
    v_pk_fma_f16 v102, v106, v249, v102 op_sel:[0,1,0] op_sel_hi:[1,1,1] neg_lo:[1,0,0] neg_hi:[1,0,0]
    v_pk_fma_f16 v110, v106, v249, v110 op_sel:[0,0,0] op_sel_hi:[1,0,1]
    v_pk_mul_f16 v103, v99, v249 op_sel:[0,0] op_sel_hi:[1,0]
    v_pk_mul_f16 v111, v99, v249 op_sel:[0,1] op_sel_hi:[1,1]
    v_pk_fma_f16 v103, v107, v249, v103 op_sel:[0,1,0] op_sel_hi:[1,1,1] neg_lo:[1,0,0] neg_hi:[1,0,0]
    v_pk_fma_f16 v111, v107, v249, v111 op_sel:[0,0,0] op_sel_hi:[1,0,1]
    v_cvt_pk_f16_f32 v224, v160, v161
    v_cvt_pk_f16_f32 v225, v162, v163
    v_mfma_f32_32x32x16_f16 v[128:143], v[100:103], v[52:55], v[128:143]
    v_cvt_pk_f16_f32 v226, v164, v165
    v_cvt_pk_f16_f32 v227, v166, v167
    v_cvt_pk_f16_f32 v228, v168, v169
    v_cvt_pk_f16_f32 v229, v170, v171
    v_cvt_pk_f16_f32 v230, v172, v173
    v_cvt_pk_f16_f32 v231, v174, v175
    v_mfma_f32_32x32x16_f16 v[144:159], v[108:111], v[52:55], v[144:159]
    v_cvt_pk_f16_f32 v232, -v176, -v177
    v_cvt_pk_f16_f32 v233, -v178, -v179
    v_cvt_pk_f16_f32 v234, -v180, -v181
    v_cvt_pk_f16_f32 v235, -v182, -v183
    v_cvt_pk_f16_f32 v236, -v184, -v185
    v_cvt_pk_f16_f32 v237, -v186, -v187
    v_mfma_f32_32x32x16_f16 v[32:47], v[224:227], v[192:195], 0
    v_cvt_pk_f16_f32 v238, -v188, -v189
    v_cvt_pk_f16_f32 v239, -v190, -v191
    s_add_u32 s46, s50, 69632
    s_waitcnt vmcnt(0)
    s_barrier
    s_cmp_lg_u32 s36, 0
    s_cbranch_scc1 L_noflag_1
    v_lshlrev_b32 v29, 2, v1
    v_mov_b32 v30, s40
    s_mov_b32 exec_hi, 0
    buffer_store_dword v30, v29, s[4:7], s46 offen sc1
    s_mov_b64 exec, -1
L_noflag_1:
.p2align 3
    v_pk_mul_f16 v113, v112, v241 op_sel:[0,0] op_sel_hi:[1,0]
    v_mfma_f32_32x32x16_f16 v[32:47], v[228:231], v[196:199], v[32:47]
    v_pk_mul_f16 v121, v112, v241 op_sel:[0,1] op_sel_hi:[1,1]
    v_pk_fma_f16 v113, v120, v241, v113 op_sel:[0,1,0] op_sel_hi:[1,1,1] neg_lo:[1,0,0] neg_hi:[1,0,0]
    v_pk_fma_f16 v121, v120, v241, v121 op_sel:[0,0,0] op_sel_hi:[1,0,1]
    v_pk_mul_f16 v114, v112, v243 op_sel:[0,0] op_sel_hi:[1,0]
    v_pk_mul_f16 v122, v112, v243 op_sel:[0,1] op_sel_hi:[1,1]
    v_pk_fma_f16 v114, v120, v243, v114 op_sel:[0,1,0] op_sel_hi:[1,1,1] neg_lo:[1,0,0] neg_hi:[1,0,0]
    v_mfma_f32_32x32x16_f16 v[32:47], v[232:235], v[200:203], v[32:47]
    v_pk_fma_f16 v122, v120, v243, v122 op_sel:[0,0,0] op_sel_hi:[1,0,1]
    v_pk_mul_f16 v115, v113, v243 op_sel:[0,0] op_sel_hi:[1,0]
    v_pk_mul_f16 v123, v113, v243 op_sel:[0,1] op_sel_hi:[1,1]
    v_pk_fma_f16 v115, v121, v243, v115 op_sel:[0,1,0] op_sel_hi:[1,1,1] neg_lo:[1,0,0] neg_hi:[1,0,0]
    v_pk_fma_f16 v123, v121, v243, v123 op_sel:[0,0,0] op_sel_hi:[1,0,1]
    v_pk_mul_f16 v116, v112, v251 op_sel:[0,0] op_sel_hi:[1,0]
    v_mfma_f32_32x32x16_f16 v[32:47], v[236:239], v[204:207], v[32:47]
    v_pk_mul_f16 v124, v112, v251 op_sel:[0,1] op_sel_hi:[1,1]
    v_pk_fma_f16 v116, v120, v251, v116 op_sel:[0,1,0] op_sel_hi:[1,1,1] neg_lo:[1,0,0] neg_hi:[1,0,0]
    v_pk_fma_f16 v124, v120, v251, v124 op_sel:[0,0,0] op_sel_hi:[1,0,1]
    v_pk_mul_f16 v117, v253, v251 op_sel:[0,0] op_sel_hi:[1,0]
    v_pk_mul_f16 v125, v253, v251 op_sel:[0,1] op_sel_hi:[1,1]
    v_pk_fma_f16 v117, v255, v251, v117 op_sel:[0,1,0] op_sel_hi:[1,1,1] neg_lo:[1,0,0] neg_hi:[1,0,0]
    v_mfma_f32_32x32x16_f16 v[160:175], v[112:115], v[56:59], 0
    v_pk_fma_f16 v125, v255, v251, v125 op_sel:[0,0,0] op_sel_hi:[1,0,1]
    v_perm_b32 v116, v116, v253, s57
    v_perm_b32 v124, v124, v255, s57
    v_pk_mul_f16 v118, v117, v251 op_sel:[0,0] op_sel_hi:[1,0]
    v_pk_mul_f16 v126, v117, v251 op_sel:[0,1] op_sel_hi:[1,1]
    v_pk_fma_f16 v118, v125, v251, v118 op_sel:[0,1,0] op_sel_hi:[1,1,1] neg_lo:[1,0,0] neg_hi:[1,0,0]
    v_mfma_f32_32x32x16_f16 v[176:191], v[120:123], v[56:59], 0
    v_pk_fma_f16 v126, v125, v251, v126 op_sel:[0,0,0] op_sel_hi:[1,0,1]
    v_pk_mul_f16 v119, v118, v251 op_sel:[0,0] op_sel_hi:[1,0]
    v_pk_mul_f16 v127, v118, v251 op_sel:[0,1] op_sel_hi:[1,1]
    v_pk_fma_f16 v119, v126, v251, v119 op_sel:[0,1,0] op_sel_hi:[1,1,1] neg_lo:[1,0,0] neg_hi:[1,0,0]
    v_pk_fma_f16 v127, v126, v251, v127 op_sel:[0,0,0] op_sel_hi:[1,0,1]
    v_cvt_pk_f16_f32 v208, v128, v129
    v_cvt_pk_f16_f32 v209, v130, v131
    v_mfma_f32_32x32x16_f16 v[160:175], v[116:119], v[60:63], v[160:175]
    v_cvt_pk_f16_f32 v210, v132, v133
    v_cvt_pk_f16_f32 v211, v134, v135
    v_cvt_pk_f16_f32 v212, v136, v137
    v_cvt_pk_f16_f32 v213, v138, v139
    v_cvt_pk_f16_f32 v214, v140, v141
    v_cvt_pk_f16_f32 v215, v142, v143
    v_mfma_f32_32x32x16_f16 v[176:191], v[124:127], v[60:63], v[176:191]
    v_cvt_pk_f16_f32 v216, v144, v145
    v_cvt_pk_f16_f32 v217, v146, v147
    v_cvt_pk_f16_f32 v218, v148, v149
    v_cvt_pk_f16_f32 v219, v150, v151
    v_cvt_pk_f16_f32 v220, v152, v153
    v_cvt_pk_f16_f32 v221, v154, v155
    v_cvt_pk_f16_f32 v222, v156, v157
    v_cvt_pk_f16_f32 v223, v158, v159
    v_and_b32 v16, 0xffff0000, v12
    v_and_b32 v17, 0xffff0000, v13
    v_and_b32 v18, 0xffff0000, v14
    v_and_b32 v19, 0xffff0000, v15
    v_mul_f32 v29, s52, v16
    v_fma_f32 v30, v16, s52, -v29
    v_exp_f32 v29, v29
    v_fma_f32 v30, v16, s53, v30
    v_mul_f32 v30, s54, v30
    v_fma_f32 v29, v29, v30, v29
    v_cvt_pk_bf16_f32 v29, v29, v29
    v_lshlrev_b32 v16, 16, v29
    v_mul_f32 v17, v17, v5
    v_mul_f32 v16, v16, v4
    v_fract_f32 v66, v17
    v_exp_f32 v92, v16
    v_cos_f32 v65, v66
    v_sin_f32 v66, v66
    v_mul_f32 v65, v65, v92
    v_mul_f32 v66, v66, v92
    v_mul_f32 v75, s56, v17
    v_mul_f32 v92, s56, v16
    v_fract_f32 v75, v75
    v_exp_f32 v92, v92
    v_cos_f32 v74, v75
    v_sin_f32 v75, v75
    v_mul_f32 v74, v74, v92
    v_mul_f32 v75, v75, v92
    v_mul_f32 v84, s58, v17
    v_mul_f32 v92, s58, v16
    v_fract_f32 v84, v84
    v_exp_f32 v92, v92
    v_cos_f32 v83, v84
    v_sin_f32 v84, v84
    v_mul_f32 v83, v83, v92
    v_mul_f32 v84, v84, v92
    v_mul_f32 v67, v65, v65
    v_mul_f32 v68, v65, v66 mul:2
    v_fma_f32 v67, -v66, v66, v67
    v_mul_f32 v69, v67, v67
    v_mul_f32 v70, v67, v68 mul:2
    v_fma_f32 v69, -v68, v68, v69
    v_mul_f32 v71, v69, v69
    v_mul_f32 v73, v69, v70 mul:2
    v_fma_f32 v71, -v70, v70, v71
    v_mul_f32 v76, v74, v74
    v_mul_f32 v77, v74, v75 mul:2
    v_fma_f32 v76, -v75, v75, v76
    v_mul_f32 v78, v76, v76
    v_mul_f32 v79, v76, v77 mul:2
    v_fma_f32 v78, -v77, v77, v78
    v_mul_f32 v81, v78, v78
    v_mul_f32 v82, v78, v79 mul:2
    v_fma_f32 v81, -v79, v79, v81
    v_mul_f32 v85, v83, v83
    v_mul_f32 v86, v83, v84 mul:2
    v_fma_f32 v85, -v84, v84, v85
    v_mul_f32 v18, s60, v18
    v_mul_f32 v19, s60, v19
    v_mul_f32 v87, v18, v69
    v_mul_f32 v89, v18, v70
    v_fma_f32 v87, -v19, v70, v87
    v_fmac_f32 v89, v19, v69
    v_mul_f32 v90, v18, v71
    v_mul_f32 v91, v18, v73
    v_fma_f32 v90, -v19, v73, v90
    v_fmac_f32 v91, v19, v71
    v_cvt_pk_f16_f32 v240, v65, v66
    v_cvt_pk_f16_f32 v242, v67, v68
    v_cvt_pk_f16_f32 v244, v74, v75
    v_cvt_pk_f16_f32 v246, v76, v77
    v_cvt_pk_f16_f32 v248, v78, v79
    v_cvt_pk_f16_f32 v250, v85, v86
    v_cvt_pk_f16_f32 v94, v81, v82
    v_cvt_pk_f16_f32 v95, v83, v84
    v_mov_b32 v241, v240
    v_mov_b32 v243, v242
    v_mov_b32 v245, v244
    v_mov_b32 v247, v246
    v_mov_b32 v249, v248
    v_mov_b32 v251, v250
    v_cvt_pk_f16_f32 v64, 1.0, v71
    v_cvt_pk_f16_f32 v72, 0, v73
    v_cvt_pk_f16_f32 v80, v18, v87
    v_cvt_pk_f16_f32 v88, v19, v89
    v_cvt_pk_f16_f32 v252, v18, v90
    v_cvt_pk_f16_f32 v254, v19, v91
    v_pk_mul_f16 v96, v64, v94 op_sel:[0,0] op_sel_hi:[1,0]
    v_pk_mul_f16 v104, v64, v94 op_sel:[0,1] op_sel_hi:[1,1]
    v_pk_fma_f16 v96, v72, v94, v96 op_sel:[0,1,0] op_sel_hi:[1,1,1] neg_lo:[1,0,0] neg_hi:[1,0,0]
    v_pk_fma_f16 v104, v72, v94, v104 op_sel:[0,0,0] op_sel_hi:[1,0,1]
    v_pk_mul_f16 v112, v80, v95 op_sel:[0,0] op_sel_hi:[1,0]
    v_pk_mul_f16 v120, v80, v95 op_sel:[0,1] op_sel_hi:[1,1]
    v_pk_fma_f16 v112, v88, v95, v112 op_sel:[0,1,0] op_sel_hi:[1,1,1] neg_lo:[1,0,0] neg_hi:[1,0,0]
    v_pk_fma_f16 v120, v88, v95, v120 op_sel:[0,0,0] op_sel_hi:[1,0,1]
    v_pk_mul_f16 v253, v252, v95 op_sel:[0,0] op_sel_hi:[1,0]
    v_pk_mul_f16 v255, v252, v95 op_sel:[0,1] op_sel_hi:[1,1]
    v_pk_fma_f16 v253, v254, v95, v253 op_sel:[0,1,0] op_sel_hi:[1,1,1] neg_lo:[1,0,0] neg_hi:[1,0,0]
    v_pk_fma_f16 v255, v254, v95, v255 op_sel:[0,0,0] op_sel_hi:[1,0,1]
    v_permlane32_swap_b32 v240, v241
    v_permlane32_swap_b32 v242, v243
    v_permlane32_swap_b32 v244, v245
    v_permlane32_swap_b32 v246, v247
    v_permlane32_swap_b32 v248, v249
    v_permlane32_swap_b32 v250, v251
    v_permlane32_swap_b32 v64, v96
    v_permlane32_swap_b32 v72, v104
    v_permlane32_swap_b32 v80, v112
    v_permlane32_swap_b32 v88, v120
    v_permlane32_swap_b32 v252, v253
    v_permlane32_swap_b32 v254, v255
.p2align 3
    v_pk_mul_f16 v65, v64, v244 op_sel:[0,0] op_sel_hi:[1,0]
    v_pk_mul_f16 v73, v64, v244 op_sel:[0,1] op_sel_hi:[1,1]
    v_pk_fma_f16 v65, v72, v244, v65 op_sel:[0,1,0] op_sel_hi:[1,1,1] neg_lo:[1,0,0] neg_hi:[1,0,0]
    v_pk_fma_f16 v73, v72, v244, v73 op_sel:[0,0,0] op_sel_hi:[1,0,1]
    v_pk_mul_f16 v66, v64, v246 op_sel:[0,0] op_sel_hi:[1,0]
    v_pk_mul_f16 v74, v64, v246 op_sel:[0,1] op_sel_hi:[1,1]
    v_pk_fma_f16 v66, v72, v246, v66 op_sel:[0,1,0] op_sel_hi:[1,1,1] neg_lo:[1,0,0] neg_hi:[1,0,0]
    v_pk_fma_f16 v74, v72, v246, v74 op_sel:[0,0,0] op_sel_hi:[1,0,1]
    v_pk_mul_f16 v67, v65, v246 op_sel:[0,0] op_sel_hi:[1,0]
    v_pk_mul_f16 v75, v65, v246 op_sel:[0,1] op_sel_hi:[1,1]
    v_pk_fma_f16 v67, v73, v246, v67 op_sel:[0,1,0] op_sel_hi:[1,1,1] neg_lo:[1,0,0] neg_hi:[1,0,0]
    v_pk_fma_f16 v75, v73, v246, v75 op_sel:[0,0,0] op_sel_hi:[1,0,1]
    v_pk_mul_f16 v68, v64, v248 op_sel:[0,0] op_sel_hi:[1,0]
    v_pk_mul_f16 v76, v64, v248 op_sel:[0,1] op_sel_hi:[1,1]
    v_mfma_f32_32x32x16_f16 v[128:143], v[64:67], v[48:51], 0
    v_pk_fma_f16 v68, v72, v248, v68 op_sel:[0,1,0] op_sel_hi:[1,1,1] neg_lo:[1,0,0] neg_hi:[1,0,0]
    v_pk_fma_f16 v76, v72, v248, v76 op_sel:[0,0,0] op_sel_hi:[1,0,1]
    v_pk_mul_f16 v69, v65, v248 op_sel:[0,0] op_sel_hi:[1,0]
    v_pk_mul_f16 v77, v65, v248 op_sel:[0,1] op_sel_hi:[1,1]
    v_pk_fma_f16 v69, v73, v248, v69 op_sel:[0,1,0] op_sel_hi:[1,1,1] neg_lo:[1,0,0] neg_hi:[1,0,0]
    v_pk_fma_f16 v77, v73, v248, v77 op_sel:[0,0,0] op_sel_hi:[1,0,1]
    v_mfma_f32_32x32x16_f16 v[144:159], v[72:75], v[48:51], 0
    v_pk_mul_f16 v70, v66, v248 op_sel:[0,0] op_sel_hi:[1,0]
    v_pk_mul_f16 v78, v66, v248 op_sel:[0,1] op_sel_hi:[1,1]
    v_pk_fma_f16 v70, v74, v248, v70 op_sel:[0,1,0] op_sel_hi:[1,1,1] neg_lo:[1,0,0] neg_hi:[1,0,0]
    v_pk_fma_f16 v78, v74, v248, v78 op_sel:[0,0,0] op_sel_hi:[1,0,1]
    v_pk_mul_f16 v71, v67, v248 op_sel:[0,0] op_sel_hi:[1,0]
    v_pk_mul_f16 v79, v67, v248 op_sel:[0,1] op_sel_hi:[1,1]
    v_pk_fma_f16 v71, v75, v248, v71 op_sel:[0,1,0] op_sel_hi:[1,1,1] neg_lo:[1,0,0] neg_hi:[1,0,0]
    v_pk_fma_f16 v79, v75, v248, v79 op_sel:[0,0,0] op_sel_hi:[1,0,1]
    v_cvt_pk_f16_f32 v224, v160, v161
    v_cvt_pk_f16_f32 v225, v162, v163
    v_mfma_f32_32x32x16_f16 v[128:143], v[68:71], v[52:55], v[128:143]
    v_cvt_pk_f16_f32 v226, v164, v165
    v_cvt_pk_f16_f32 v227, v166, v167
    v_cvt_pk_f16_f32 v228, v168, v169
    v_cvt_pk_f16_f32 v229, v170, v171
    v_cvt_pk_f16_f32 v230, v172, v173
    v_cvt_pk_f16_f32 v231, v174, v175
    v_mfma_f32_32x32x16_f16 v[144:159], v[76:79], v[52:55], v[144:159]
    v_cvt_pk_f16_f32 v232, -v176, -v177
    v_cvt_pk_f16_f32 v233, -v178, -v179
    v_cvt_pk_f16_f32 v234, -v180, -v181
    v_cvt_pk_f16_f32 v235, -v182, -v183
    v_cvt_pk_f16_f32 v236, -v184, -v185
    v_cvt_pk_f16_f32 v237, -v186, -v187
    v_mfma_f32_32x32x16_f16 v[32:47], v[224:227], v[208:211], v[32:47]
    v_cvt_pk_f16_f32 v238, -v188, -v189
    v_cvt_pk_f16_f32 v239, -v190, -v191
    s_branch L_pg_A2
.p2align 12
L_stub_A2:
    s_branch L_backA
    s_nop 0
L_pg_A2:
    v_pk_mul_f16 v81, v80, v240 op_sel:[0,0] op_sel_hi:[1,0]
    v_pk_mul_f16 v89, v80, v240 op_sel:[0,1] op_sel_hi:[1,1]
    v_pk_fma_f16 v81, v88, v240, v81 op_sel:[0,1,0] op_sel_hi:[1,1,1] neg_lo:[1,0,0] neg_hi:[1,0,0]
    v_mfma_f32_32x32x16_f16 v[32:47], v[228:231], v[212:215], v[32:47]
    v_pk_fma_f16 v89, v88, v240, v89 op_sel:[0,0,0] op_sel_hi:[1,0,1]
    v_pk_mul_f16 v82, v80, v242 op_sel:[0,0] op_sel_hi:[1,0]
    v_pk_mul_f16 v90, v80, v242 op_sel:[0,1] op_sel_hi:[1,1]
    v_pk_fma_f16 v82, v88, v242, v82 op_sel:[0,1,0] op_sel_hi:[1,1,1] neg_lo:[1,0,0] neg_hi:[1,0,0]
    v_pk_fma_f16 v90, v88, v242, v90 op_sel:[0,0,0] op_sel_hi:[1,0,1]
    v_pk_mul_f16 v83, v81, v242 op_sel:[0,0] op_sel_hi:[1,0]
    v_mfma_f32_32x32x16_f16 v[32:47], v[232:235], v[216:219], v[32:47]
    v_pk_mul_f16 v91, v81, v242 op_sel:[0,1] op_sel_hi:[1,1]
    v_pk_fma_f16 v83, v89, v242, v83 op_sel:[0,1,0] op_sel_hi:[1,1,1] neg_lo:[1,0,0] neg_hi:[1,0,0]
    v_pk_fma_f16 v91, v89, v242, v91 op_sel:[0,0,0] op_sel_hi:[1,0,1]
    v_pk_mul_f16 v84, v80, v250 op_sel:[0,0] op_sel_hi:[1,0]
    v_pk_mul_f16 v92, v80, v250 op_sel:[0,1] op_sel_hi:[1,1]
    v_pk_fma_f16 v84, v88, v250, v84 op_sel:[0,1,0] op_sel_hi:[1,1,1] neg_lo:[1,0,0] neg_hi:[1,0,0]
    v_mfma_f32_32x32x16_f16 v[32:47], v[236:239], v[220:223], v[32:47]
    v_pk_fma_f16 v92, v88, v250, v92 op_sel:[0,0,0] op_sel_hi:[1,0,1]
    v_pk_mul_f16 v85, v252, v250 op_sel:[0,0] op_sel_hi:[1,0]
    v_pk_mul_f16 v93, v252, v250 op_sel:[0,1] op_sel_hi:[1,1]
    v_pk_fma_f16 v85, v254, v250, v85 op_sel:[0,1,0] op_sel_hi:[1,1,1] neg_lo:[1,0,0] neg_hi:[1,0,0]
    v_pk_fma_f16 v93, v254, v250, v93 op_sel:[0,0,0] op_sel_hi:[1,0,1]
    v_perm_b32 v84, v84, v252, s57
    v_mfma_f32_32x32x16_f16 v[160:175], v[80:83], v[56:59], 0
    v_perm_b32 v92, v92, v254, s57
    v_pk_mul_f16 v86, v85, v250 op_sel:[0,0] op_sel_hi:[1,0]
    v_pk_mul_f16 v94, v85, v250 op_sel:[0,1] op_sel_hi:[1,1]
    v_pk_fma_f16 v86, v93, v250, v86 op_sel:[0,1,0] op_sel_hi:[1,1,1] neg_lo:[1,0,0] neg_hi:[1,0,0]
    v_pk_fma_f16 v94, v93, v250, v94 op_sel:[0,0,0] op_sel_hi:[1,0,1]
    v_pk_mul_f16 v87, v86, v250 op_sel:[0,0] op_sel_hi:[1,0]
    v_mfma_f32_32x32x16_f16 v[176:191], v[88:91], v[56:59], 0
    v_pk_mul_f16 v95, v86, v250 op_sel:[0,1] op_sel_hi:[1,1]
    v_pk_fma_f16 v87, v94, v250, v87 op_sel:[0,1,0] op_sel_hi:[1,1,1] neg_lo:[1,0,0] neg_hi:[1,0,0]
    v_pk_fma_f16 v95, v94, v250, v95 op_sel:[0,0,0] op_sel_hi:[1,0,1]
    v_cvt_pk_f16_f32 v192, v128, v129
    v_cvt_pk_f16_f32 v193, v130, v131
    v_cvt_pk_f16_f32 v194, v132, v133
    v_mfma_f32_32x32x16_f16 v[160:175], v[84:87], v[60:63], v[160:175]
    v_cvt_pk_f16_f32 v195, v134, v135
    v_cvt_pk_f16_f32 v196, v136, v137
    v_cvt_pk_f16_f32 v197, v138, v139
    v_cvt_pk_f16_f32 v198, v140, v141
    v_cvt_pk_f16_f32 v199, v142, v143
    v_cvt_pk_f16_f32 v200, v144, v145
    v_mfma_f32_32x32x16_f16 v[176:191], v[92:95], v[60:63], v[176:191]
    v_cvt_pk_f16_f32 v201, v146, v147
    v_cvt_pk_f16_f32 v202, v148, v149
    v_cvt_pk_f16_f32 v203, v150, v151
    v_cvt_pk_f16_f32 v204, v152, v153
    v_cvt_pk_f16_f32 v205, v154, v155
    v_cvt_pk_f16_f32 v206, v156, v157
    v_cvt_pk_f16_f32 v207, v158, v159
    v_pk_mul_f16 v97, v96, v245 op_sel:[0,0] op_sel_hi:[1,0]
    v_pk_mul_f16 v105, v96, v245 op_sel:[0,1] op_sel_hi:[1,1]
    v_pk_fma_f16 v97, v104, v245, v97 op_sel:[0,1,0] op_sel_hi:[1,1,1] neg_lo:[1,0,0] neg_hi:[1,0,0]
    v_pk_fma_f16 v105, v104, v245, v105 op_sel:[0,0,0] op_sel_hi:[1,0,1]
    v_pk_mul_f16 v98, v96, v247 op_sel:[0,0] op_sel_hi:[1,0]
    v_pk_mul_f16 v106, v96, v247 op_sel:[0,1] op_sel_hi:[1,1]
    v_pk_fma_f16 v98, v104, v247, v98 op_sel:[0,1,0] op_sel_hi:[1,1,1] neg_lo:[1,0,0] neg_hi:[1,0,0]
    v_pk_fma_f16 v106, v104, v247, v106 op_sel:[0,0,0] op_sel_hi:[1,0,1]
    v_pk_mul_f16 v99, v97, v247 op_sel:[0,0] op_sel_hi:[1,0]
    v_pk_mul_f16 v107, v97, v247 op_sel:[0,1] op_sel_hi:[1,1]
    v_pk_fma_f16 v99, v105, v247, v99 op_sel:[0,1,0] op_sel_hi:[1,1,1] neg_lo:[1,0,0] neg_hi:[1,0,0]
    v_pk_fma_f16 v107, v105, v247, v107 op_sel:[0,0,0] op_sel_hi:[1,0,1]
    v_pk_mul_f16 v100, v96, v249 op_sel:[0,0] op_sel_hi:[1,0]
    v_pk_mul_f16 v108, v96, v249 op_sel:[0,1] op_sel_hi:[1,1]
    v_mfma_f32_32x32x16_f16 v[128:143], v[96:99], v[48:51], 0
    v_pk_fma_f16 v100, v104, v249, v100 op_sel:[0,1,0] op_sel_hi:[1,1,1] neg_lo:[1,0,0] neg_hi:[1,0,0]
    v_pk_fma_f16 v108, v104, v249, v108 op_sel:[0,0,0] op_sel_hi:[1,0,1]
    v_pk_mul_f16 v101, v97, v249 op_sel:[0,0] op_sel_hi:[1,0]
    v_pk_mul_f16 v109, v97, v249 op_sel:[0,1] op_sel_hi:[1,1]
    v_pk_fma_f16 v101, v105, v249, v101 op_sel:[0,1,0] op_sel_hi:[1,1,1] neg_lo:[1,0,0] neg_hi:[1,0,0]
    v_pk_fma_f16 v109, v105, v249, v109 op_sel:[0,0,0] op_sel_hi:[1,0,1]
    v_mfma_f32_32x32x16_f16 v[144:159], v[104:107], v[48:51], 0
    v_pk_mul_f16 v102, v98, v249 op_sel:[0,0] op_sel_hi:[1,0]
    v_pk_mul_f16 v110, v98, v249 op_sel:[0,1] op_sel_hi:[1,1]
    v_pk_fma_f16 v102, v106, v249, v102 op_sel:[0,1,0] op_sel_hi:[1,1,1] neg_lo:[1,0,0] neg_hi:[1,0,0]
    v_pk_fma_f16 v110, v106, v249, v110 op_sel:[0,0,0] op_sel_hi:[1,0,1]
    v_pk_mul_f16 v103, v99, v249 op_sel:[0,0] op_sel_hi:[1,0]
    v_pk_mul_f16 v111, v99, v249 op_sel:[0,1] op_sel_hi:[1,1]
    v_pk_fma_f16 v103, v107, v249, v103 op_sel:[0,1,0] op_sel_hi:[1,1,1] neg_lo:[1,0,0] neg_hi:[1,0,0]
    v_pk_fma_f16 v111, v107, v249, v111 op_sel:[0,0,0] op_sel_hi:[1,0,1]
    v_cvt_pk_f16_f32 v224, v160, v161
    v_cvt_pk_f16_f32 v225, v162, v163
    v_mfma_f32_32x32x16_f16 v[128:143], v[100:103], v[52:55], v[128:143]
    v_cvt_pk_f16_f32 v226, v164, v165
    v_cvt_pk_f16_f32 v227, v166, v167
    v_cvt_pk_f16_f32 v228, v168, v169
    v_cvt_pk_f16_f32 v229, v170, v171
    v_cvt_pk_f16_f32 v230, v172, v173
    v_cvt_pk_f16_f32 v231, v174, v175
    v_mfma_f32_32x32x16_f16 v[144:159], v[108:111], v[52:55], v[144:159]
    v_cvt_pk_f16_f32 v232, -v176, -v177
    v_cvt_pk_f16_f32 v233, -v178, -v179
    v_cvt_pk_f16_f32 v234, -v180, -v181
    v_cvt_pk_f16_f32 v235, -v182, -v183
    v_cvt_pk_f16_f32 v236, -v184, -v185
    v_cvt_pk_f16_f32 v237, -v186, -v187
    v_mfma_f32_32x32x16_f16 v[32:47], v[224:227], v[192:195], v[32:47]
    v_cvt_pk_f16_f32 v238, -v188, -v189
    v_cvt_pk_f16_f32 v239, -v190, -v191
    v_pk_mul_f16 v113, v112, v241 op_sel:[0,0] op_sel_hi:[1,0]
    v_pk_mul_f16 v121, v112, v241 op_sel:[0,1] op_sel_hi:[1,1]
    v_pk_fma_f16 v113, v120, v241, v113 op_sel:[0,1,0] op_sel_hi:[1,1,1] neg_lo:[1,0,0] neg_hi:[1,0,0]
    v_pk_fma_f16 v121, v120, v241, v121 op_sel:[0,0,0] op_sel_hi:[1,0,1]
    v_mfma_f32_32x32x16_f16 v[32:47], v[228:231], v[196:199], v[32:47]
    v_pk_mul_f16 v114, v112, v243 op_sel:[0,0] op_sel_hi:[1,0]
    v_pk_mul_f16 v122, v112, v243 op_sel:[0,1] op_sel_hi:[1,1]
    v_pk_fma_f16 v114, v120, v243, v114 op_sel:[0,1,0] op_sel_hi:[1,1,1] neg_lo:[1,0,0] neg_hi:[1,0,0]
    v_pk_fma_f16 v122, v120, v243, v122 op_sel:[0,0,0] op_sel_hi:[1,0,1]
    v_pk_mul_f16 v115, v113, v243 op_sel:[0,0] op_sel_hi:[1,0]
    v_pk_mul_f16 v123, v113, v243 op_sel:[0,1] op_sel_hi:[1,1]
    v_mfma_f32_32x32x16_f16 v[32:47], v[232:235], v[200:203], v[32:47]
    v_pk_fma_f16 v115, v121, v243, v115 op_sel:[0,1,0] op_sel_hi:[1,1,1] neg_lo:[1,0,0] neg_hi:[1,0,0]
    v_pk_fma_f16 v123, v121, v243, v123 op_sel:[0,0,0] op_sel_hi:[1,0,1]
    v_pk_mul_f16 v116, v112, v251 op_sel:[0,0] op_sel_hi:[1,0]
    v_pk_mul_f16 v124, v112, v251 op_sel:[0,1] op_sel_hi:[1,1]
    v_pk_fma_f16 v116, v120, v251, v116 op_sel:[0,1,0] op_sel_hi:[1,1,1] neg_lo:[1,0,0] neg_hi:[1,0,0]
    v_pk_fma_f16 v124, v120, v251, v124 op_sel:[0,0,0] op_sel_hi:[1,0,1]
    v_mfma_f32_32x32x16_f16 v[32:47], v[236:239], v[204:207], v[32:47]
    v_pk_mul_f16 v117, v253, v251 op_sel:[0,0] op_sel_hi:[1,0]
    v_pk_mul_f16 v125, v253, v251 op_sel:[0,1] op_sel_hi:[1,1]
    v_pk_fma_f16 v117, v255, v251, v117 op_sel:[0,1,0] op_sel_hi:[1,1,1] neg_lo:[1,0,0] neg_hi:[1,0,0]
    v_pk_fma_f16 v125, v255, v251, v125 op_sel:[0,0,0] op_sel_hi:[1,0,1]
    v_perm_b32 v116, v116, v253, s57
    v_perm_b32 v124, v124, v255, s57
    v_mfma_f32_32x32x16_f16 v[160:175], v[112:115], v[56:59], 0
    v_pk_mul_f16 v118, v117, v251 op_sel:[0,0] op_sel_hi:[1,0]
    v_pk_mul_f16 v126, v117, v251 op_sel:[0,1] op_sel_hi:[1,1]
    v_pk_fma_f16 v118, v125, v251, v118 op_sel:[0,1,0] op_sel_hi:[1,1,1] neg_lo:[1,0,0] neg_hi:[1,0,0]
    v_pk_fma_f16 v126, v125, v251, v126 op_sel:[0,0,0] op_sel_hi:[1,0,1]
    v_pk_mul_f16 v119, v118, v251 op_sel:[0,0] op_sel_hi:[1,0]
    v_pk_mul_f16 v127, v118, v251 op_sel:[0,1] op_sel_hi:[1,1]
    v_mfma_f32_32x32x16_f16 v[176:191], v[120:123], v[56:59], 0
    v_pk_fma_f16 v119, v126, v251, v119 op_sel:[0,1,0] op_sel_hi:[1,1,1] neg_lo:[1,0,0] neg_hi:[1,0,0]
    v_pk_fma_f16 v127, v126, v251, v127 op_sel:[0,0,0] op_sel_hi:[1,0,1]
    v_cvt_pk_f16_f32 v208, v128, v129
    v_cvt_pk_f16_f32 v209, v130, v131
    v_cvt_pk_f16_f32 v210, v132, v133
    v_cvt_pk_f16_f32 v211, v134, v135
    v_mfma_f32_32x32x16_f16 v[160:175], v[116:119], v[60:63], v[160:175]
    v_cvt_pk_f16_f32 v212, v136, v137
    v_cvt_pk_f16_f32 v213, v138, v139
    v_cvt_pk_f16_f32 v214, v140, v141
    v_cvt_pk_f16_f32 v215, v142, v143
    v_cvt_pk_f16_f32 v216, v144, v145
    v_cvt_pk_f16_f32 v217, v146, v147
    v_mfma_f32_32x32x16_f16 v[176:191], v[124:127], v[60:63], v[176:191]
    v_cvt_pk_f16_f32 v218, v148, v149
    v_cvt_pk_f16_f32 v219, v150, v151
    v_cvt_pk_f16_f32 v220, v152, v153
    v_cvt_pk_f16_f32 v221, v154, v155
    v_cvt_pk_f16_f32 v222, v156, v157
    v_cvt_pk_f16_f32 v223, v158, v159
    s_cmp_lg_u32 s36, 0
    s_cbranch_scc1 L_nopoll_2
    buffer_load_dword v7, v6, s[4:7], 0 offen sc1
L_nopoll_2:
    v_cvt_pk_f16_f32 v224, v160, v161
    v_cvt_pk_f16_f32 v225, v162, v163
    v_cvt_pk_f16_f32 v226, v164, v165
    v_cvt_pk_f16_f32 v227, v166, v167
    v_cvt_pk_f16_f32 v228, v168, v169
    v_cvt_pk_f16_f32 v229, v170, v171
    v_mfma_f32_32x32x16_f16 v[32:47], v[224:227], v[208:211], v[32:47]
    v_cvt_pk_f16_f32 v230, v172, v173
    v_cvt_pk_f16_f32 v231, v174, v175
    v_cvt_pk_f16_f32 v232, -v176, -v177
    v_cvt_pk_f16_f32 v233, -v178, -v179
    v_cvt_pk_f16_f32 v234, -v180, -v181
    v_cvt_pk_f16_f32 v235, -v182, -v183
    v_mfma_f32_32x32x16_f16 v[32:47], v[228:231], v[212:215], v[32:47]
    v_cvt_pk_f16_f32 v236, -v184, -v185
    v_cvt_pk_f16_f32 v237, -v186, -v187
    v_cvt_pk_f16_f32 v238, -v188, -v189
    v_cvt_pk_f16_f32 v239, -v190, -v191
    v_mfma_f32_32x32x16_f16 v[32:47], v[232:235], v[216:219], v[32:47]
    s_nop 0
    v_mfma_f32_32x32x16_f16 v[32:47], v[236:239], v[220:223], v[32:47]
    v_add_f32 v31, v11, v11
    v_mul_f32 v31, s61, v31
    s_lshl_b32 s47, s36, 12
    v_lshl_add_u32 v8, v1, 4, s47
    v_xor_b32 v9, 4096, v8
    s_mul_i32 s46, s44, 16640
    s_lshl_b32 s47, s45, 11
    s_add_u32 s47, s47, s46
    v_lshl_add_u32 v12, v1, 4, s47
    s_nop 2
    v_mul_f32 v32, v31, v32
    v_mul_f32 v33, v31, v33
    v_mul_f32 v34, v31, v34
    v_mul_f32 v35, v31, v35
    ds_write_b128 v8, v[32:35] offset:60416
    v_mul_f32 v36, v31, v36
    v_mul_f32 v37, v31, v37
    v_mul_f32 v38, v31, v38
    v_mul_f32 v39, v31, v39
    ds_write_b128 v8, v[36:39] offset:61440
    v_mul_f32 v40, v31, v40
    v_mul_f32 v41, v31, v41
    v_mul_f32 v42, v31, v42
    v_mul_f32 v43, v31, v43
    ds_write_b128 v8, v[40:43] offset:62464
    v_mul_f32 v44, v31, v44
    v_mul_f32 v45, v31, v45
    v_mul_f32 v46, v31, v46
    ds_write_b128 v8, v[44:47] offset:63488
    s_lshl_b32 s47, s39, 13
    s_add_u32 s47, s47, 6422528
    v_lshlrev_b32 v10, 5, v0
    s_cmp_lg_u32 s36, 0
    s_cbranch_scc1 L_uback
    s_waitcnt vmcnt(0)
    v_cmp_ne_u32 vcc, s40, v7
    s_nop 1
    s_cbranch_vccnz L_uwait
L_uback:
    v_and_b32 v13, 1, v1
    v_cmp_eq_u32 s[62:63], 1, v13
    s_waitcnt lgkmcnt(0)
    s_barrier
    buffer_load_dwordx4 v[20:23], v10, s[4:7], s47 offen sc1
    buffer_load_dwordx4 v[24:27], v10, s[4:7], s47 offen offset:16 sc1
    ds_read_b128 v[48:51], v9 offset:60416
    ds_read_b128 v[52:55], v9 offset:61440
    ds_read_b128 v[56:59], v9 offset:62464
    ds_read_b128 v[60:63], v9 offset:63488
    v_and_b32 v14, 15, v1
    v_lshrrev_b32 v15, 4, v1
    v_lshlrev_b32 v16, 3, v15
    v_sub_u32 v16, v14, v16
    v_add_u32 v16, 25, v16
    v_sub_u32 v17, 0, v16
    v_and_b32 v17, 3, v17
    v_add_u32 v16, v16, v17
    v_mul_u32_u24 v17, 4160, v17
    v_lshl_add_u32 v16, v16, 1, v17
    s_lshl_b32 s47, s45, 9
    s_add_u32 s47, s47, s46
    v_add_u32 v2, s47, v16
    s_mul_i32 s47, s44, 7584
    s_mul_i32 s48, s45, 768
    s_sub_u32 s47, s47, s48
    s_add_u32 s47, s47, 36864
    v_mul_u32_u24 v3, 96, v14
    v_lshl_add_u32 v3, v15, 4, v3
    v_add_u32 v3, s47, v3
    s_mul_i32 s47, s36, 9216
    v_mul_u32_u24 v4, 144, v14
    v_lshl_add_u32 v4, v15, 4, v4
    v_add_u32 v4, s47, v4
    v_lshrrev_b32 v5, 3, v0
    v_mul_u32_u24 v5, 144, v5
    v_and_b32 v16, 7, v0
    v_lshl_add_u32 v5, v16, 4, v5
    s_cmp_eq_u32 s45, 1
    s_cbranch_scc1 L_x1
    s_mov_b64 exec, 1
    v_add_f32 v32, s43, v32
    s_mov_b64 exec, -1
    s_waitcnt lgkmcnt(1)
    v_add_f32 v32, v32, v48
    v_add_f32 v33, v33, v49
    v_add_f32 v34, v34, v50
    v_add_f32 v35, v35, v51
    v_add_f32 v36, v36, v52
    v_add_f32 v37, v37, v53
    v_add_f32 v38, v38, v54
    v_add_f32 v39, v39, v55
    v_add_f32 v40, v40, v56
    v_add_f32 v41, v41, v57
    v_add_f32 v42, v42, v58
    v_cvt_pk_bf16_f32 v66, v32, v33
    v_cvt_pk_bf16_f32 v67, v34, v35
    v_cvt_pk_bf16_f32 v68, v36, v37
    v_cvt_pk_bf16_f32 v69, v38, v39
    v_cvt_pk_bf16_f32 v72, v40, v40
    v_cvt_pk_bf16_f32 v73, v40, v41
    v_cvt_pk_bf16_f32 v74, v41, v41
    v_cvt_pk_bf16_f32 v75, v42, v42
    v_mov_b32 v64, 0
    v_mov_b32 v65, 0
    s_nop 0
    v_mov_b32_dpp v64, v68 wave_shr:1 row_mask:0xf bank_mask:0xf
    v_mov_b32_dpp v65, v69 wave_shr:1 row_mask:0xf bank_mask:0xf
    s_branch L_x2
L_x1:
    s_waitcnt lgkmcnt(0)
    v_add_f32 v41, v41, v57
    v_add_f32 v42, v42, v58
    v_add_f32 v43, v43, v59
    v_add_f32 v44, v44, v60
    v_add_f32 v45, v45, v61
    v_add_f32 v46, v46, v62
    v_cvt_pk_bf16_f32 v76, v41, v41
    v_cvt_pk_bf16_f32 v77, v42, v42
    v_cndmask_b32 v13, v43, v44, s[62:63]
    v_cvt_pk_bf16_f32 v66, v43, v43
    v_cvt_pk_bf16_f32 v67, v43, v43
    v_cvt_pk_bf16_f32 v68, v13, v44
    v_cvt_pk_bf16_f32 v69, v44, v44
    v_cndmask_b32 v13, v45, v46, s[62:63]
    v_cvt_pk_bf16_f32 v72, v45, v45
    v_cvt_pk_bf16_f32 v73, v45, v45
    v_cvt_pk_bf16_f32 v74, v13, v46
    v_cvt_pk_bf16_f32 v75, v46, v46
    v_mov_b32_dpp v64, v76 wave_ror:1 row_mask:0xf bank_mask:0xf
    v_mov_b32_dpp v65, v77 wave_ror:1 row_mask:0xf bank_mask:0xf
    s_nop 0
    v_mov_b32_dpp v64, v68 wave_shr:1 row_mask:0xf bank_mask:0xf
    v_mov_b32_dpp v65, v69 wave_shr:1 row_mask:0xf bank_mask:0xf
L_x2:
    v_mov_b32_dpp v70, v68 wave_ror:1 row_mask:0xf bank_mask:0xf
    v_mov_b32_dpp v71, v69 wave_ror:1 row_mask:0xf bank_mask:0xf
    s_nop 0
    v_mov_b32_dpp v70, v74 wave_shr:1 row_mask:0xf bank_mask:0xf
    v_mov_b32_dpp v71, v75 wave_shr:1 row_mask:0xf bank_mask:0xf
    ds_write_b128 v12, v[66:69] offset:64
    v_alignbit_b32 v80, v66, v65, 16
    v_alignbit_b32 v81, v67, v66, 16
    v_alignbit_b32 v82, v68, v67, 16
    v_alignbit_b32 v83, v69, v68, 16
    ds_write_b128 v12, v[80:83] offset:4224
    v_mov_b32 v84, v65
    v_mov_b32 v85, v66
    v_mov_b32 v86, v67
    v_mov_b32 v87, v68
    ds_write_b128 v12, v[84:87] offset:8384
    v_alignbit_b32 v88, v65, v64, 16
    v_alignbit_b32 v89, v66, v65, 16
    v_alignbit_b32 v90, v67, v66, 16
    v_alignbit_b32 v91, v68, v67, 16
    ds_write_b128 v12, v[88:91] offset:12544
    ds_write_b128 v12, v[72:75] offset:1088
    v_alignbit_b32 v92, v72, v71, 16
    v_alignbit_b32 v93, v73, v72, 16
    v_alignbit_b32 v94, v74, v73, 16
    v_alignbit_b32 v95, v75, v74, 16
    ds_write_b128 v12, v[92:95] offset:5248
    v_mov_b32 v96, v71
    v_mov_b32 v97, v72
    v_mov_b32 v98, v73
    v_mov_b32 v99, v74
    ds_write_b128 v12, v[96:99] offset:9408
    v_alignbit_b32 v100, v71, v70, 16
    v_alignbit_b32 v101, v72, v71, 16
    v_alignbit_b32 v102, v73, v72, 16
    v_alignbit_b32 v103, v74, v73, 16
    ds_write_b128 v12, v[100:103] offset:13568
    v_lshrrev_b32 v13, 2, v0
    v_mul_u32_u24 v13, 96, v13
    v_and_b32 v16, 3, v0
    v_lshl_add_u32 v13, v16, 4, v13
    s_mov_b32 s47, 0x05040100
    s_mov_b32 s48, 0x07060302
    s_waitcnt vmcnt(0)
    v_perm_b32 v104, v26, v27, s47
    v_perm_b32 v105, v24, v25, s47
    v_perm_b32 v106, v22, v23, s47
    v_perm_b32 v107, v20, v21, s47
    ds_write_b128 v13, v[104:107] offset:38304
    v_perm_b32 v108, v26, v27, s48
    v_perm_b32 v109, v24, v25, s48
    v_perm_b32 v110, v22, v23, s48
    v_perm_b32 v111, v20, v21, s48
    ds_write_b128 v13, v[108:111] offset:45888
    s_branch L_pg_A3
.p2align 12
L_stub_A3:
    s_branch L_backA
    s_nop 0
L_pg_A3:
    s_setprio 0
    s_waitcnt lgkmcnt(0)
    s_barrier
    ds_read_b128 v[96:99], v3 offset:1440
    ds_read_b128 v[100:103], v3 offset:2976
    ds_read_b128 v[104:107], v3 offset:4512
    ds_read_b128 v[108:111], v3 offset:6048
    ds_read_b64 v[64:65], v2 offset:0
    ds_read_b64 v[66:67], v2 offset:8
    ds_read_b64 v[68:69], v2 offset:32
    ds_read_b64 v[70:71], v2 offset:40
    ds_read_b64 v[72:73], v2 offset:1024
    ds_read_b64 v[74:75], v2 offset:1032
    ds_read_b64 v[76:77], v2 offset:1056
    ds_read_b64 v[78:79], v2 offset:1064
    ds_read_b64 v[80:81], v2 offset:2048
    ds_read_b64 v[82:83], v2 offset:2056
    ds_read_b64 v[84:85], v2 offset:2080
    ds_read_b64 v[86:87], v2 offset:2088
    ds_read_b64 v[88:89], v2 offset:3072
    ds_read_b64 v[90:91], v2 offset:3080
    ds_read_b64 v[92:93], v2 offset:3104
    ds_read_b64 v[94:95], v2 offset:3112
    s_waitcnt lgkmcnt(12)
    v_mfma_f32_16x16x32_bf16 v[32:35], v[64:67], v[96:99], 0
    ds_read_b128 v[144:147], v3 offset:1344
    v_mfma_f32_16x16x32_bf16 v[36:39], v[68:71], v[96:99], 0
    ds_read_b128 v[148:151], v3 offset:2880
    v_mfma_f32_16x16x32_bf16 v[40:43], v[64:67], v[100:103], 0
    ds_read_b128 v[152:155], v3 offset:4416
    v_mfma_f32_16x16x32_bf16 v[44:47], v[68:71], v[100:103], 0
    ds_read_b128 v[156:159], v3 offset:5952
    v_mfma_f32_16x16x32_bf16 v[48:51], v[64:67], v[104:107], 0
    ds_read_b64 v[112:113], v2 offset:64
    v_mfma_f32_16x16x32_bf16 v[52:55], v[68:71], v[104:107], 0
    ds_read_b64 v[114:115], v2 offset:72
    v_mfma_f32_16x16x32_bf16 v[56:59], v[64:67], v[108:111], 0
    ds_read_b64 v[116:117], v2 offset:96
    v_mfma_f32_16x16x32_bf16 v[60:63], v[68:71], v[108:111], 0
    ds_read_b64 v[118:119], v2 offset:104
    s_waitcnt lgkmcnt(15)
    v_mfma_f32_16x16x32_bf16 v[40:43], v[72:75], v[96:99], v[40:43]
    ds_read_b64 v[120:121], v2 offset:1088
    v_mfma_f32_16x16x32_bf16 v[44:47], v[76:79], v[96:99], v[44:47]
    ds_read_b64 v[122:123], v2 offset:1096
    v_mfma_f32_16x16x32_bf16 v[48:51], v[72:75], v[100:103], v[48:51]
    ds_read_b64 v[124:125], v2 offset:1120
    v_mfma_f32_16x16x32_bf16 v[52:55], v[76:79], v[100:103], v[52:55]
    ds_read_b64 v[126:127], v2 offset:1128
    v_mfma_f32_16x16x32_bf16 v[56:59], v[72:75], v[104:107], v[56:59]
    ds_read_b64 v[128:129], v2 offset:2112
    v_mfma_f32_16x16x32_bf16 v[60:63], v[76:79], v[104:107], v[60:63]
    ds_read_b64 v[130:131], v2 offset:2120
    s_waitcnt lgkmcnt(15)
    v_mfma_f32_16x16x32_bf16 v[48:51], v[80:83], v[96:99], v[48:51]
    ds_read_b64 v[132:133], v2 offset:2144
    v_mfma_f32_16x16x32_bf16 v[52:55], v[84:87], v[96:99], v[52:55]
    ds_read_b64 v[134:135], v2 offset:2152
    v_mfma_f32_16x16x32_bf16 v[56:59], v[80:83], v[100:103], v[56:59]
    ds_read_b64 v[136:137], v2 offset:3136
    v_mfma_f32_16x16x32_bf16 v[60:63], v[84:87], v[100:103], v[60:63]
    ds_read_b64 v[138:139], v2 offset:3144
    s_waitcnt lgkmcnt(15)
    v_mfma_f32_16x16x32_bf16 v[56:59], v[88:91], v[96:99], v[56:59]
    ds_read_b64 v[140:141], v2 offset:3168
    v_mfma_f32_16x16x32_bf16 v[60:63], v[92:95], v[96:99], v[60:63]
    ds_read_b64 v[142:143], v2 offset:3176
    s_waitcnt lgkmcnt(12)
    v_mfma_f32_16x16x32_bf16 v[32:35], v[112:115], v[144:147], v[32:35]
    ds_read_b128 v[96:99], v3 offset:1248
    v_mfma_f32_16x16x32_bf16 v[36:39], v[116:119], v[144:147], v[36:39]
    ds_read_b128 v[100:103], v3 offset:2784
    v_mfma_f32_16x16x32_bf16 v[40:43], v[112:115], v[148:151], v[40:43]
    ds_read_b128 v[104:107], v3 offset:4320
    v_mfma_f32_16x16x32_bf16 v[44:47], v[116:119], v[148:151], v[44:47]
    ds_read_b128 v[108:111], v3 offset:5856
    v_mfma_f32_16x16x32_bf16 v[48:51], v[112:115], v[152:155], v[48:51]
    ds_read_b64 v[64:65], v2 offset:128
    v_mfma_f32_16x16x32_bf16 v[52:55], v[116:119], v[152:155], v[52:55]
    ds_read_b64 v[66:67], v2 offset:136
    v_mfma_f32_16x16x32_bf16 v[56:59], v[112:115], v[156:159], v[56:59]
    ds_read_b64 v[68:69], v2 offset:160
    v_mfma_f32_16x16x32_bf16 v[60:63], v[116:119], v[156:159], v[60:63]
    ds_read_b64 v[70:71], v2 offset:168
    s_waitcnt lgkmcnt(15)
    v_mfma_f32_16x16x32_bf16 v[40:43], v[120:123], v[144:147], v[40:43]
    ds_read_b64 v[72:73], v2 offset:1152
    v_mfma_f32_16x16x32_bf16 v[44:47], v[124:127], v[144:147], v[44:47]
    ds_read_b64 v[74:75], v2 offset:1160
    v_mfma_f32_16x16x32_bf16 v[48:51], v[120:123], v[148:151], v[48:51]
    ds_read_b64 v[76:77], v2 offset:1184
    v_mfma_f32_16x16x32_bf16 v[52:55], v[124:127], v[148:151], v[52:55]
    ds_read_b64 v[78:79], v2 offset:1192
    v_mfma_f32_16x16x32_bf16 v[56:59], v[120:123], v[152:155], v[56:59]
    ds_read_b64 v[80:81], v2 offset:2176
    v_mfma_f32_16x16x32_bf16 v[60:63], v[124:127], v[152:155], v[60:63]
    ds_read_b64 v[82:83], v2 offset:2184
    s_waitcnt lgkmcnt(15)
    v_mfma_f32_16x16x32_bf16 v[48:51], v[128:131], v[144:147], v[48:51]
    ds_read_b64 v[84:85], v2 offset:2208
    v_mfma_f32_16x16x32_bf16 v[52:55], v[132:135], v[144:147], v[52:55]
    ds_read_b64 v[86:87], v2 offset:2216
    v_mfma_f32_16x16x32_bf16 v[56:59], v[128:131], v[148:151], v[56:59]
    ds_read_b64 v[88:89], v2 offset:3200
    v_mfma_f32_16x16x32_bf16 v[60:63], v[132:135], v[148:151], v[60:63]
    ds_read_b64 v[90:91], v2 offset:3208
    s_waitcnt lgkmcnt(15)
    v_mfma_f32_16x16x32_bf16 v[56:59], v[136:139], v[144:147], v[56:59]
    ds_read_b64 v[92:93], v2 offset:3232
    v_mfma_f32_16x16x32_bf16 v[60:63], v[140:143], v[144:147], v[60:63]
    ds_read_b64 v[94:95], v2 offset:3240
    s_waitcnt lgkmcnt(12)
    v_mfma_f32_16x16x32_bf16 v[32:35], v[64:67], v[96:99], v[32:35]
    ds_read_b128 v[144:147], v3 offset:1152
    v_mfma_f32_16x16x32_bf16 v[36:39], v[68:71], v[96:99], v[36:39]
    ds_read_b128 v[148:151], v3 offset:2688
    v_mfma_f32_16x16x32_bf16 v[40:43], v[64:67], v[100:103], v[40:43]
    ds_read_b128 v[152:155], v3 offset:4224
    v_mfma_f32_16x16x32_bf16 v[44:47], v[68:71], v[100:103], v[44:47]
    ds_read_b128 v[156:159], v3 offset:5760
    v_mfma_f32_16x16x32_bf16 v[48:51], v[64:67], v[104:107], v[48:51]
    ds_read_b64 v[112:113], v2 offset:192
    v_mfma_f32_16x16x32_bf16 v[52:55], v[68:71], v[104:107], v[52:55]
    ds_read_b64 v[114:115], v2 offset:200
    v_mfma_f32_16x16x32_bf16 v[56:59], v[64:67], v[108:111], v[56:59]
    ds_read_b64 v[116:117], v2 offset:224
    v_mfma_f32_16x16x32_bf16 v[60:63], v[68:71], v[108:111], v[60:63]
    ds_read_b64 v[118:119], v2 offset:232
    s_waitcnt lgkmcnt(15)
    v_mfma_f32_16x16x32_bf16 v[40:43], v[72:75], v[96:99], v[40:43]
    ds_read_b64 v[120:121], v2 offset:1216
    v_mfma_f32_16x16x32_bf16 v[44:47], v[76:79], v[96:99], v[44:47]
    ds_read_b64 v[122:123], v2 offset:1224
    v_mfma_f32_16x16x32_bf16 v[48:51], v[72:75], v[100:103], v[48:51]
    ds_read_b64 v[124:125], v2 offset:1248
    v_mfma_f32_16x16x32_bf16 v[52:55], v[76:79], v[100:103], v[52:55]
    ds_read_b64 v[126:127], v2 offset:1256
    v_mfma_f32_16x16x32_bf16 v[56:59], v[72:75], v[104:107], v[56:59]
    ds_read_b64 v[128:129], v2 offset:2240
    v_mfma_f32_16x16x32_bf16 v[60:63], v[76:79], v[104:107], v[60:63]
    ds_read_b64 v[130:131], v2 offset:2248
    s_waitcnt lgkmcnt(15)
    v_mfma_f32_16x16x32_bf16 v[48:51], v[80:83], v[96:99], v[48:51]
    ds_read_b64 v[132:133], v2 offset:2272
    v_mfma_f32_16x16x32_bf16 v[52:55], v[84:87], v[96:99], v[52:55]
    ds_read_b64 v[134:135], v2 offset:2280
    v_mfma_f32_16x16x32_bf16 v[56:59], v[80:83], v[100:103], v[56:59]
    ds_read_b64 v[136:137], v2 offset:3264
    v_mfma_f32_16x16x32_bf16 v[60:63], v[84:87], v[100:103], v[60:63]
    ds_read_b64 v[138:139], v2 offset:3272
    s_waitcnt lgkmcnt(15)
    v_mfma_f32_16x16x32_bf16 v[56:59], v[88:91], v[96:99], v[56:59]
    ds_read_b64 v[140:141], v2 offset:3296
    v_mfma_f32_16x16x32_bf16 v[60:63], v[92:95], v[96:99], v[60:63]
    ds_read_b64 v[142:143], v2 offset:3304
    s_waitcnt lgkmcnt(12)
    v_mfma_f32_16x16x32_bf16 v[32:35], v[112:115], v[144:147], v[32:35]
    ds_read_b128 v[96:99], v3 offset:1056
    v_mfma_f32_16x16x32_bf16 v[36:39], v[116:119], v[144:147], v[36:39]
    ds_read_b128 v[100:103], v3 offset:2592
    v_mfma_f32_16x16x32_bf16 v[40:43], v[112:115], v[148:151], v[40:43]
    ds_read_b128 v[104:107], v3 offset:4128
    v_mfma_f32_16x16x32_bf16 v[44:47], v[116:119], v[148:151], v[44:47]
    ds_read_b128 v[108:111], v3 offset:5664
    v_mfma_f32_16x16x32_bf16 v[48:51], v[112:115], v[152:155], v[48:51]
    ds_read_b64 v[64:65], v2 offset:256
    v_mfma_f32_16x16x32_bf16 v[52:55], v[116:119], v[152:155], v[52:55]
    ds_read_b64 v[66:67], v2 offset:264
    v_mfma_f32_16x16x32_bf16 v[56:59], v[112:115], v[156:159], v[56:59]
    ds_read_b64 v[68:69], v2 offset:288
    v_mfma_f32_16x16x32_bf16 v[60:63], v[116:119], v[156:159], v[60:63]
    ds_read_b64 v[70:71], v2 offset:296
    s_waitcnt lgkmcnt(15)
    v_mfma_f32_16x16x32_bf16 v[40:43], v[120:123], v[144:147], v[40:43]
    ds_read_b64 v[72:73], v2 offset:1280
    v_mfma_f32_16x16x32_bf16 v[44:47], v[124:127], v[144:147], v[44:47]
    ds_read_b64 v[74:75], v2 offset:1288
    v_mfma_f32_16x16x32_bf16 v[48:51], v[120:123], v[148:151], v[48:51]
    ds_read_b64 v[76:77], v2 offset:1312
    v_mfma_f32_16x16x32_bf16 v[52:55], v[124:127], v[148:151], v[52:55]
    ds_read_b64 v[78:79], v2 offset:1320
    v_mfma_f32_16x16x32_bf16 v[56:59], v[120:123], v[152:155], v[56:59]
    ds_read_b64 v[80:81], v2 offset:2304
    v_mfma_f32_16x16x32_bf16 v[60:63], v[124:127], v[152:155], v[60:63]
    ds_read_b64 v[82:83], v2 offset:2312
    s_waitcnt lgkmcnt(15)
    v_mfma_f32_16x16x32_bf16 v[48:51], v[128:131], v[144:147], v[48:51]
    ds_read_b64 v[84:85], v2 offset:2336
    v_mfma_f32_16x16x32_bf16 v[52:55], v[132:135], v[144:147], v[52:55]
    ds_read_b64 v[86:87], v2 offset:2344
    v_mfma_f32_16x16x32_bf16 v[56:59], v[128:131], v[148:151], v[56:59]
    ds_read_b64 v[88:89], v2 offset:3328
    v_mfma_f32_16x16x32_bf16 v[60:63], v[132:135], v[148:151], v[60:63]
    ds_read_b64 v[90:91], v2 offset:3336
    s_waitcnt lgkmcnt(15)
    v_mfma_f32_16x16x32_bf16 v[56:59], v[136:139], v[144:147], v[56:59]
    ds_read_b64 v[92:93], v2 offset:3360
    v_mfma_f32_16x16x32_bf16 v[60:63], v[140:143], v[144:147], v[60:63]
    ds_read_b64 v[94:95], v2 offset:3368
    s_waitcnt lgkmcnt(12)
    v_mfma_f32_16x16x32_bf16 v[32:35], v[64:67], v[96:99], v[32:35]
    ds_read_b128 v[144:147], v3 offset:960
    v_mfma_f32_16x16x32_bf16 v[36:39], v[68:71], v[96:99], v[36:39]
    ds_read_b128 v[148:151], v3 offset:2496
    v_mfma_f32_16x16x32_bf16 v[40:43], v[64:67], v[100:103], v[40:43]
    ds_read_b128 v[152:155], v3 offset:4032
    v_mfma_f32_16x16x32_bf16 v[44:47], v[68:71], v[100:103], v[44:47]
    ds_read_b128 v[156:159], v3 offset:5568
    v_mfma_f32_16x16x32_bf16 v[48:51], v[64:67], v[104:107], v[48:51]
    ds_read_b64 v[112:113], v2 offset:320
    v_mfma_f32_16x16x32_bf16 v[52:55], v[68:71], v[104:107], v[52:55]
    ds_read_b64 v[114:115], v2 offset:328
    v_mfma_f32_16x16x32_bf16 v[56:59], v[64:67], v[108:111], v[56:59]
    ds_read_b64 v[116:117], v2 offset:352
    v_mfma_f32_16x16x32_bf16 v[60:63], v[68:71], v[108:111], v[60:63]
    ds_read_b64 v[118:119], v2 offset:360
    s_waitcnt lgkmcnt(15)
    v_mfma_f32_16x16x32_bf16 v[40:43], v[72:75], v[96:99], v[40:43]
    ds_read_b64 v[120:121], v2 offset:1344
    v_mfma_f32_16x16x32_bf16 v[44:47], v[76:79], v[96:99], v[44:47]
    ds_read_b64 v[122:123], v2 offset:1352
    v_mfma_f32_16x16x32_bf16 v[48:51], v[72:75], v[100:103], v[48:51]
    ds_read_b64 v[124:125], v2 offset:1376
    v_mfma_f32_16x16x32_bf16 v[52:55], v[76:79], v[100:103], v[52:55]
    ds_read_b64 v[126:127], v2 offset:1384
    v_mfma_f32_16x16x32_bf16 v[56:59], v[72:75], v[104:107], v[56:59]
    ds_read_b64 v[128:129], v2 offset:2368
    v_mfma_f32_16x16x32_bf16 v[60:63], v[76:79], v[104:107], v[60:63]
    ds_read_b64 v[130:131], v2 offset:2376
    s_waitcnt lgkmcnt(15)
    v_mfma_f32_16x16x32_bf16 v[48:51], v[80:83], v[96:99], v[48:51]
    ds_read_b64 v[132:133], v2 offset:2400
    v_mfma_f32_16x16x32_bf16 v[52:55], v[84:87], v[96:99], v[52:55]
    ds_read_b64 v[134:135], v2 offset:2408
    v_mfma_f32_16x16x32_bf16 v[56:59], v[80:83], v[100:103], v[56:59]
    ds_read_b64 v[136:137], v2 offset:3392
    v_mfma_f32_16x16x32_bf16 v[60:63], v[84:87], v[100:103], v[60:63]
    ds_read_b64 v[138:139], v2 offset:3400
    s_waitcnt lgkmcnt(15)
    v_mfma_f32_16x16x32_bf16 v[56:59], v[88:91], v[96:99], v[56:59]
    ds_read_b64 v[140:141], v2 offset:3424
    v_mfma_f32_16x16x32_bf16 v[60:63], v[92:95], v[96:99], v[60:63]
    ds_read_b64 v[142:143], v2 offset:3432
    s_waitcnt lgkmcnt(12)
    v_mfma_f32_16x16x32_bf16 v[32:35], v[112:115], v[144:147], v[32:35]
    ds_read_b128 v[96:99], v3 offset:864
    v_mfma_f32_16x16x32_bf16 v[36:39], v[116:119], v[144:147], v[36:39]
    ds_read_b128 v[100:103], v3 offset:2400
    v_mfma_f32_16x16x32_bf16 v[40:43], v[112:115], v[148:151], v[40:43]
    ds_read_b128 v[104:107], v3 offset:3936
    v_mfma_f32_16x16x32_bf16 v[44:47], v[116:119], v[148:151], v[44:47]
    ds_read_b128 v[108:111], v3 offset:5472
    v_mfma_f32_16x16x32_bf16 v[48:51], v[112:115], v[152:155], v[48:51]
    ds_read_b64 v[64:65], v2 offset:384
    v_mfma_f32_16x16x32_bf16 v[52:55], v[116:119], v[152:155], v[52:55]
    ds_read_b64 v[66:67], v2 offset:392
    v_mfma_f32_16x16x32_bf16 v[56:59], v[112:115], v[156:159], v[56:59]
    ds_read_b64 v[68:69], v2 offset:416
    v_mfma_f32_16x16x32_bf16 v[60:63], v[116:119], v[156:159], v[60:63]
    ds_read_b64 v[70:71], v2 offset:424
    s_waitcnt lgkmcnt(15)
    v_mfma_f32_16x16x32_bf16 v[40:43], v[120:123], v[144:147], v[40:43]
    ds_read_b64 v[72:73], v2 offset:1408
    v_mfma_f32_16x16x32_bf16 v[44:47], v[124:127], v[144:147], v[44:47]
    ds_read_b64 v[74:75], v2 offset:1416
    v_mfma_f32_16x16x32_bf16 v[48:51], v[120:123], v[148:151], v[48:51]
    ds_read_b64 v[76:77], v2 offset:1440
    v_mfma_f32_16x16x32_bf16 v[52:55], v[124:127], v[148:151], v[52:55]
    ds_read_b64 v[78:79], v2 offset:1448
    v_mfma_f32_16x16x32_bf16 v[56:59], v[120:123], v[152:155], v[56:59]
    ds_read_b64 v[80:81], v2 offset:2432
    v_mfma_f32_16x16x32_bf16 v[60:63], v[124:127], v[152:155], v[60:63]
    ds_read_b64 v[82:83], v2 offset:2440
    s_waitcnt lgkmcnt(15)
    v_mfma_f32_16x16x32_bf16 v[48:51], v[128:131], v[144:147], v[48:51]
    ds_read_b64 v[84:85], v2 offset:2464
    v_mfma_f32_16x16x32_bf16 v[52:55], v[132:135], v[144:147], v[52:55]
    ds_read_b64 v[86:87], v2 offset:2472
    v_mfma_f32_16x16x32_bf16 v[56:59], v[128:131], v[148:151], v[56:59]
    ds_read_b64 v[88:89], v2 offset:3456
    v_mfma_f32_16x16x32_bf16 v[60:63], v[132:135], v[148:151], v[60:63]
    ds_read_b64 v[90:91], v2 offset:3464
    s_waitcnt lgkmcnt(15)
    v_mfma_f32_16x16x32_bf16 v[56:59], v[136:139], v[144:147], v[56:59]
    ds_read_b64 v[92:93], v2 offset:3488
    v_mfma_f32_16x16x32_bf16 v[60:63], v[140:143], v[144:147], v[60:63]
    ds_read_b64 v[94:95], v2 offset:3496
    s_waitcnt lgkmcnt(12)
    v_mfma_f32_16x16x32_bf16 v[32:35], v[64:67], v[96:99], v[32:35]
    ds_read_b128 v[144:147], v3 offset:768
    v_mfma_f32_16x16x32_bf16 v[36:39], v[68:71], v[96:99], v[36:39]
    ds_read_b128 v[148:151], v3 offset:2304
    v_mfma_f32_16x16x32_bf16 v[40:43], v[64:67], v[100:103], v[40:43]
    ds_read_b128 v[152:155], v3 offset:3840
    v_mfma_f32_16x16x32_bf16 v[44:47], v[68:71], v[100:103], v[44:47]
    ds_read_b128 v[156:159], v3 offset:5376
    v_mfma_f32_16x16x32_bf16 v[48:51], v[64:67], v[104:107], v[48:51]
    ds_read_b64 v[112:113], v2 offset:448
    v_mfma_f32_16x16x32_bf16 v[52:55], v[68:71], v[104:107], v[52:55]
    ds_read_b64 v[114:115], v2 offset:456
    v_mfma_f32_16x16x32_bf16 v[56:59], v[64:67], v[108:111], v[56:59]
    ds_read_b64 v[116:117], v2 offset:480
    v_mfma_f32_16x16x32_bf16 v[60:63], v[68:71], v[108:111], v[60:63]
    ds_read_b64 v[118:119], v2 offset:488
    s_waitcnt lgkmcnt(15)
    v_mfma_f32_16x16x32_bf16 v[40:43], v[72:75], v[96:99], v[40:43]
    ds_read_b64 v[120:121], v2 offset:1472
    v_mfma_f32_16x16x32_bf16 v[44:47], v[76:79], v[96:99], v[44:47]
    ds_read_b64 v[122:123], v2 offset:1480
    v_mfma_f32_16x16x32_bf16 v[48:51], v[72:75], v[100:103], v[48:51]
    ds_read_b64 v[124:125], v2 offset:1504
    v_mfma_f32_16x16x32_bf16 v[52:55], v[76:79], v[100:103], v[52:55]
    ds_read_b64 v[126:127], v2 offset:1512
    v_mfma_f32_16x16x32_bf16 v[56:59], v[72:75], v[104:107], v[56:59]
    ds_read_b64 v[128:129], v2 offset:2496
    v_mfma_f32_16x16x32_bf16 v[60:63], v[76:79], v[104:107], v[60:63]
    ds_read_b64 v[130:131], v2 offset:2504
    s_waitcnt lgkmcnt(15)
    v_mfma_f32_16x16x32_bf16 v[48:51], v[80:83], v[96:99], v[48:51]
    ds_read_b64 v[132:133], v2 offset:2528
    v_mfma_f32_16x16x32_bf16 v[52:55], v[84:87], v[96:99], v[52:55]
    ds_read_b64 v[134:135], v2 offset:2536
    v_mfma_f32_16x16x32_bf16 v[56:59], v[80:83], v[100:103], v[56:59]
    ds_read_b64 v[136:137], v2 offset:3520
    v_mfma_f32_16x16x32_bf16 v[60:63], v[84:87], v[100:103], v[60:63]
    ds_read_b64 v[138:139], v2 offset:3528
    s_waitcnt lgkmcnt(15)
    v_mfma_f32_16x16x32_bf16 v[56:59], v[88:91], v[96:99], v[56:59]
    ds_read_b64 v[140:141], v2 offset:3552
    v_mfma_f32_16x16x32_bf16 v[60:63], v[92:95], v[96:99], v[60:63]
    ds_read_b64 v[142:143], v2 offset:3560
    s_waitcnt lgkmcnt(12)
    v_mfma_f32_16x16x32_bf16 v[32:35], v[112:115], v[144:147], v[32:35]
    v_mfma_f32_16x16x32_bf16 v[36:39], v[116:119], v[144:147], v[36:39]
    v_mfma_f32_16x16x32_bf16 v[40:43], v[112:115], v[148:151], v[40:43]
    v_mfma_f32_16x16x32_bf16 v[44:47], v[116:119], v[148:151], v[44:47]
    v_mfma_f32_16x16x32_bf16 v[48:51], v[112:115], v[152:155], v[48:51]
    v_mfma_f32_16x16x32_bf16 v[52:55], v[116:119], v[152:155], v[52:55]
    v_mfma_f32_16x16x32_bf16 v[56:59], v[112:115], v[156:159], v[56:59]
    v_mfma_f32_16x16x32_bf16 v[60:63], v[116:119], v[156:159], v[60:63]
    s_waitcnt lgkmcnt(8)
    v_mfma_f32_16x16x32_bf16 v[40:43], v[120:123], v[144:147], v[40:43]
    v_mfma_f32_16x16x32_bf16 v[44:47], v[124:127], v[144:147], v[44:47]
    v_mfma_f32_16x16x32_bf16 v[48:51], v[120:123], v[148:151], v[48:51]
    v_mfma_f32_16x16x32_bf16 v[52:55], v[124:127], v[148:151], v[52:55]
    v_mfma_f32_16x16x32_bf16 v[56:59], v[120:123], v[152:155], v[56:59]
    v_mfma_f32_16x16x32_bf16 v[60:63], v[124:127], v[152:155], v[60:63]
    s_waitcnt lgkmcnt(4)
    v_mfma_f32_16x16x32_bf16 v[48:51], v[128:131], v[144:147], v[48:51]
    v_mfma_f32_16x16x32_bf16 v[52:55], v[132:135], v[144:147], v[52:55]
    v_mfma_f32_16x16x32_bf16 v[56:59], v[128:131], v[148:151], v[56:59]
    v_mfma_f32_16x16x32_bf16 v[60:63], v[132:135], v[148:151], v[60:63]
    s_waitcnt lgkmcnt(0)
    v_mfma_f32_16x16x32_bf16 v[56:59], v[136:139], v[144:147], v[56:59]
    v_mfma_f32_16x16x32_bf16 v[60:63], v[140:143], v[144:147], v[60:63]
    s_setprio 3
    s_barrier
    ds_write_b128 v4, v[32:35] offset:0
    ds_write_b128 v4, v[36:39] offset:64
    ds_write_b128 v4, v[40:43] offset:2304
    ds_write_b128 v4, v[44:47] offset:2368
    ds_write_b128 v4, v[48:51] offset:4608
    ds_write_b128 v4, v[52:55] offset:4672
    ds_write_b128 v4, v[56:59] offset:6912
    ds_write_b128 v4, v[60:63] offset:6976
    s_lshl_b32 s47, s39, 13
    s_add_u32 s47, s47, 8392704
    s_add_u32 s48, s47, 4096
    v_lshlrev_b32 v13, 4, v0
    s_waitcnt lgkmcnt(0)
    s_barrier
    ds_read_b128 v[64:67], v5 offset:0
    ds_read_b128 v[68:71], v5 offset:9216
    ds_read_b128 v[72:75], v5 offset:18432
    ds_read_b128 v[76:79], v5 offset:27648
    ds_read_b128 v[80:83], v5 offset:4608
    ds_read_b128 v[84:87], v5 offset:13824
    ds_read_b128 v[88:91], v5 offset:23040
    ds_read_b128 v[92:95], v5 offset:32256
    s_waitcnt lgkmcnt(4)
    v_add_f32 v64, v64, v68
    v_add_f32 v65, v65, v69
    v_add_f32 v66, v66, v70
    v_add_f32 v67, v67, v71
    v_add_f32 v72, v72, v76
    v_add_f32 v73, v73, v77
    v_add_f32 v74, v74, v78
    v_add_f32 v75, v75, v79
    v_cvt_pk_bf16_f32 v96, v64, v72
    v_cvt_pk_bf16_f32 v97, v65, v73
    v_cvt_pk_bf16_f32 v98, v66, v74
    v_cvt_pk_bf16_f32 v99, v67, v75
    buffer_store_dwordx4 v[96:99], v13, s[4:7], s47 offen sc1
    s_waitcnt lgkmcnt(0)
    v_add_f32 v80, v80, v84
    v_add_f32 v81, v81, v85
    v_add_f32 v82, v82, v86
    v_add_f32 v83, v83, v87
    v_add_f32 v88, v88, v92
    v_add_f32 v89, v89, v93
    v_add_f32 v90, v90, v94
    v_add_f32 v91, v91, v95
    v_cvt_pk_bf16_f32 v100, v80, v88
    v_cvt_pk_bf16_f32 v101, v81, v89
    v_cvt_pk_bf16_f32 v102, v82, v90
    v_cvt_pk_bf16_f32 v103, v83, v91
    buffer_store_dwordx4 v[100:103], v13, s[4:7], s48 offen sc1
    v_add_u32 v6, 32768, v6
    s_lshl_b32 s47, s36, 1
    v_xor_b32 v14, s47, v14
    v_lshlrev_b32 v14, 4, v14
    v_lshl_add_u32 v2, v15, 13, v14
    v_xor_b32 v3, 16, v2
    v_add_u32 v3, 31744, v3
    s_lshl_b32 s47, s36, 2
    v_lshrrev_b32 v16, 5, v1
    v_add_u32 v16, s47, v16
    v_and_b32 v17, 7, v1
    v_xor_b32 v16, v16, v17
    v_lshlrev_b32 v16, 4, v16
    v_lshl_add_u32 v16, v17, 10, v16
    v_bfe_u32 v18, v1, 3, 2
    v_lshl_add_u32 v4, v18, 2, v16
    v_xor_b32 v5, 32, v4
    v_lshrrev_b32 v18, 3, v1
    v_mul_u32_u24 v8, 1792, v18
    v_lshl_add_u32 v8, v17, 4, v8
    s_add_u32 s46, s50, 102400
    s_waitcnt vmcnt(0)
    s_barrier
    s_cmp_lg_u32 s36, 0
    s_cbranch_scc1 L_noflag_3
    v_lshlrev_b32 v29, 2, v1
    v_mov_b32 v30, s40
    s_mov_b32 exec_hi, 0
    buffer_store_dword v30, v29, s[4:7], s46 offen sc1
    s_mov_b64 exec, -1
L_noflag_3:
    s_lshl_b32 s46, s38, 2
    s_add_u32 s46, s46, s36
    s_mul_i32 s46, s46, 28672
    s_lshl_b32 s47, s37, 7
    s_add_u32 s46, s46, s47
    s_add_u32 s48, s46, 14336
    s_add_u32 s49, s49, 8392704
    s_lshl_b32 s47, s36, 11
    s_add_u32 m0, s47, 52224
    s_cmp_lg_u32 s36, 0
    s_cbranch_scc1 L_nopoll_4
    s_waitcnt vmcnt(0)
    s_mov_b32 s41, 40000
    s_mov_b64 exec, -1
L_poll_5:
    s_sleep 48
    buffer_load_dword v7, v6, s[4:7], 0 offen sc1
L_pollchk_7:
    s_waitcnt vmcnt(0)
    v_cmp_ne_u32 vcc, s40, v7
    s_sub_u32 s41, s41, 1
    s_nop 0
    s_cbranch_vccz L_polldone_6
    s_cbranch_scc1 L_polldone_6
    s_branch L_poll_5
L_polldone_6:
    s_mov_b64 exec, -1
L_nopoll_4:
    s_barrier
    buffer_load_dwordx4 v2, s[4:7], s49 offen sc1 lds
    buffer_load_dwordx4 v3, s[4:7], s49 offen offset:1024 sc1 lds
    s_waitcnt vmcnt(0)
    s_barrier
    ds_read_b32 v20, v4 offset:52224
    ds_read_b32 v21, v4 offset:52480
    ds_read_b32 v22, v4 offset:52736
    ds_read_b32 v23, v4 offset:52992
    ds_read_b32 v24, v5 offset:52224
    ds_read_b32 v25, v5 offset:52480
    ds_read_b32 v26, v5 offset:52736
    ds_read_b32 v27, v5 offset:52992
    s_waitcnt lgkmcnt(4)
    buffer_store_dwordx4 v[20:23], v8, s[8:11], s46 offen sc1
    s_waitcnt lgkmcnt(0)
    buffer_store_dwordx4 v[24:27], v8, s[8:11], s48 offen sc1
    s_endpgm
L_idle:
    s_lshl_b32 s46, s38, 1
    s_add_u32 s46, s46, s37
    s_lshl_b32 s46, s46, 2
    s_add_u32 s46, s46, s36
    s_mul_i32 s46, s46, 3200
    v_min_u32 v2, 24, v1
    v_lshl_add_u32 v2, v2, 7, s46
    s_waitcnt lgkmcnt(0)
    s_mov_b32 s4, s22
    s_mov_b32 s5, s23
    s_mov_b32 s6, 401408
    s_mov_b32 s7, 0x00020000
    buffer_load_dword v3, v2, s[4:7], 0 offen
    s_endpgm
L_uwait:
    s_mov_b32 s41, 40000
    s_mov_b64 exec, -1
L_poll_8:
    buffer_load_dword v7, v6, s[4:7], 0 offen sc1
L_pollchk_10:
    s_waitcnt vmcnt(0)
    v_cmp_ne_u32 vcc, s40, v7
    s_sub_u32 s41, s41, 1
    s_nop 0
    s_cbranch_vccz L_polldone_9
    s_cbranch_scc1 L_polldone_9
    s_sleep 8
    s_branch L_poll_8
L_polldone_9:
    s_mov_b64 exec, -1
    s_branch L_uback
.p2align 12
L_stub_B1K:
L_pg_B1K:
    s_add_u32 m0, s57, 8192
    s_nop 0
    buffer_load_dwordx4 v6, s[8:11], s50 offen offset:0 lds
    buffer_load_dwordx4 v7, s[8:11], s50 offen offset:1024 lds
    s_add_u32 m0, s56, 16384
    s_nop 0
    buffer_load_dwordx4 v2, s[4:7], s43 offen offset:0 lds
    buffer_load_dwordx4 v3, s[4:7], s43 offen offset:1024 lds
    buffer_load_dwordx4 v4, s[4:7], s43 offen offset:2048 lds
    buffer_load_dwordx4 v5, s[4:7], s43 offen offset:3072 lds
    s_add_u32 m0, s57, 16384
    s_nop 0
    buffer_load_dwordx4 v6, s[8:11], s51 offen offset:0 lds
    buffer_load_dwordx4 v7, s[8:11], s51 offen offset:1024 lds
    s_add_u32 m0, s56, 32768
    s_nop 0
    buffer_load_dwordx4 v2, s[4:7], s44 offen offset:0 lds
    buffer_load_dwordx4 v3, s[4:7], s44 offen offset:1024 lds
    buffer_load_dwordx4 v4, s[4:7], s44 offen offset:2048 lds
    buffer_load_dwordx4 v5, s[4:7], s44 offen offset:3072 lds
    s_waitcnt vmcnt(12) lgkmcnt(0)
    s_barrier
    ds_read_b128 v[24:27], v8 offset:0
    ds_read_b64_tr_b16 v[168:169], v12 offset:0
    ds_read_b64_tr_b16 v[170:171], v12 offset:512
    ds_read_b64_tr_b16 v[172:173], v13 offset:0
    ds_read_b64_tr_b16 v[174:175], v13 offset:512
    ds_read_b128 v[28:31], v9 offset:0
    ds_read_b128 v[32:35], v10 offset:0
    ds_read_b128 v[36:39], v11 offset:0
    ds_read_b64_tr_b16 v[176:177], v12 offset:2048
    ds_read_b64_tr_b16 v[178:179], v12 offset:2560
    ds_read_b64_tr_b16 v[180:181], v13 offset:2048
    ds_read_b64_tr_b16 v[182:183], v13 offset:2560
    s_add_u32 m0, s57, 24576
    s_nop 0
    buffer_load_dwordx4 v6, s[8:11], s52 offen offset:0 lds
    buffer_load_dwordx4 v7, s[8:11], s52 offen offset:1024 lds
    s_add_u32 s41, s41, 0x9e3779b9
    s_mov_b32 s12, s28
    s_mov_b32 s13, s29
    s_mov_b32 s14, 10485760
    s_mov_b32 s15, 0x00020000
    s_add_u32 s20, s12, s18
    s_addc_u32 s21, s13, 0
    s_mov_b32 s22, 28672
    s_mov_b32 s23, 0x00020000
    s_add_u32 s24, s12, 14336
    s_addc_u32 s25, s13, 0
    s_mov_b32 s26, 10471424
    s_mov_b32 s27, 0x00020000
    s_waitcnt lgkmcnt(4)
    v_mfma_f32_32x32x16_bf16 v[136:151], v[168:171], v[24:27], 0
    ds_read_b64_tr_b16 v[184:185], v12 offset:4096
    ds_read_b64_tr_b16 v[186:187], v12 offset:4608
    v_mfma_f32_32x32x16_bf16 v[152:167], v[172:175], v[24:27], 0
    ds_read_b64_tr_b16 v[188:189], v13 offset:4096
    ds_read_b64_tr_b16 v[190:191], v13 offset:4608
    s_add_u32 m0, s56, 0
    s_nop 0
    buffer_load_dwordx4 v2, s[4:7], s45 offen offset:0 lds
    buffer_load_dwordx4 v3, s[4:7], s45 offen offset:1024 lds
    s_waitcnt lgkmcnt(4)
    v_mfma_f32_32x32x16_bf16 v[136:151], v[176:179], v[28:31], v[136:151]
    ds_read_b64_tr_b16 v[192:193], v12 offset:6144
    ds_read_b64_tr_b16 v[194:195], v12 offset:6656
    v_mfma_f32_32x32x16_bf16 v[152:167], v[180:183], v[28:31], v[152:167]
    ds_read_b64_tr_b16 v[196:197], v13 offset:6144
    ds_read_b64_tr_b16 v[198:199], v13 offset:6656
    buffer_load_dwordx4 v4, s[4:7], s45 offen offset:2048 lds
    buffer_load_dwordx4 v5, s[4:7], s45 offen offset:3072 lds
    s_waitcnt lgkmcnt(4)
    v_mfma_f32_32x32x16_bf16 v[136:151], v[184:187], v[32:35], v[136:151]
    s_waitcnt vmcnt(12) lgkmcnt(0)
    s_barrier
    ds_read_b128 v[40:43], v8 offset:16384
    ds_read_b128 v[44:47], v9 offset:16384
    ds_read_b128 v[48:51], v10 offset:16384
    ds_read_b128 v[52:55], v11 offset:16384
    v_mfma_f32_32x32x16_bf16 v[152:167], v[188:191], v[32:35], v[152:167]
    ds_read_b64_tr_b16 v[168:169], v12 offset:8192
    ds_read_b64_tr_b16 v[170:171], v12 offset:8704
    ds_read_b64_tr_b16 v[172:173], v13 offset:8192
    ds_read_b64_tr_b16 v[174:175], v13 offset:8704
    s_add_u32 m0, s57, 0
    s_nop 0
    buffer_load_dwordx4 v6, s[8:11], s53 offen offset:0 lds
    buffer_load_dwordx4 v7, s[8:11], s53 offen offset:1024 lds
    s_waitcnt lgkmcnt(4)
    v_mfma_f32_32x32x16_bf16 v[136:151], v[192:195], v[36:39], v[136:151]
    ds_read_b64_tr_b16 v[176:177], v12 offset:10240
    ds_read_b64_tr_b16 v[178:179], v12 offset:10752
    v_mfma_f32_32x32x16_bf16 v[152:167], v[196:199], v[36:39], v[152:167]
    ds_read_b64_tr_b16 v[180:181], v13 offset:10240
    ds_read_b64_tr_b16 v[182:183], v13 offset:10752
    s_add_u32 m0, s56, 16384
    s_nop 0
    buffer_load_dwordx4 v2, s[4:7], s46 offen offset:0 lds
    buffer_load_dwordx4 v3, s[4:7], s46 offen offset:1024 lds
    s_waitcnt lgkmcnt(4)
    v_mfma_f32_32x32x16_bf16 v[136:151], v[168:171], v[40:43], v[136:151]
    ds_read_b64_tr_b16 v[184:185], v12 offset:12288
    ds_read_b64_tr_b16 v[186:187], v12 offset:12800
    v_mfma_f32_32x32x16_bf16 v[152:167], v[172:175], v[40:43], v[152:167]
    ds_read_b64_tr_b16 v[188:189], v13 offset:12288
    ds_read_b64_tr_b16 v[190:191], v13 offset:12800
    buffer_load_dwordx4 v4, s[4:7], s46 offen offset:2048 lds
    buffer_load_dwordx4 v5, s[4:7], s46 offen offset:3072 lds
    s_waitcnt lgkmcnt(4)
    v_mfma_f32_32x32x16_bf16 v[136:151], v[176:179], v[44:47], v[136:151]
    ds_read_b64_tr_b16 v[192:193], v12 offset:14336
    ds_read_b64_tr_b16 v[194:195], v12 offset:14848
    v_mfma_f32_32x32x16_bf16 v[152:167], v[180:183], v[44:47], v[152:167]
    ds_read_b64_tr_b16 v[196:197], v13 offset:14336
    ds_read_b64_tr_b16 v[198:199], v13 offset:14848
    s_waitcnt lgkmcnt(4)
    v_mfma_f32_32x32x16_bf16 v[136:151], v[184:187], v[48:51], v[136:151]
    s_waitcnt vmcnt(12) lgkmcnt(0)
    s_barrier
    ds_read_b128 v[56:59], v8 offset:32768
    ds_read_b128 v[60:63], v9 offset:32768
    ds_read_b128 v[64:67], v10 offset:32768
    ds_read_b128 v[68:71], v11 offset:32768
    v_mfma_f32_32x32x16_bf16 v[152:167], v[188:191], v[48:51], v[152:167]
    ds_read_b64_tr_b16 v[168:169], v12 offset:16384
    ds_read_b64_tr_b16 v[170:171], v12 offset:16896
    ds_read_b64_tr_b16 v[172:173], v13 offset:16384
    ds_read_b64_tr_b16 v[174:175], v13 offset:16896
    s_add_u32 m0, s57, 8192
    s_nop 0
    buffer_load_dwordx4 v6, s[8:11], s54 offen offset:0 lds
    buffer_load_dwordx4 v7, s[8:11], s54 offen offset:1024 lds
    s_waitcnt lgkmcnt(4)
    v_mfma_f32_32x32x16_bf16 v[136:151], v[192:195], v[52:55], v[136:151]
    ds_read_b64_tr_b16 v[176:177], v12 offset:18432
    ds_read_b64_tr_b16 v[178:179], v12 offset:18944
    v_mfma_f32_32x32x16_bf16 v[152:167], v[196:199], v[52:55], v[152:167]
    ds_read_b64_tr_b16 v[180:181], v13 offset:18432
    ds_read_b64_tr_b16 v[182:183], v13 offset:18944
    s_add_u32 m0, s56, 32768
    s_nop 0
    buffer_load_dwordx4 v2, s[4:7], s47 offen offset:0 lds
    buffer_load_dwordx4 v3, s[4:7], s47 offen offset:1024 lds
    s_waitcnt lgkmcnt(4)
    v_mfma_f32_32x32x16_bf16 v[136:151], v[168:171], v[56:59], v[136:151]
    ds_read_b64_tr_b16 v[184:185], v12 offset:20480
    ds_read_b64_tr_b16 v[186:187], v12 offset:20992
    v_mfma_f32_32x32x16_bf16 v[152:167], v[172:175], v[56:59], v[152:167]
    ds_read_b64_tr_b16 v[188:189], v13 offset:20480
    ds_read_b64_tr_b16 v[190:191], v13 offset:20992
    buffer_load_dwordx4 v4, s[4:7], s47 offen offset:2048 lds
    buffer_load_dwordx4 v5, s[4:7], s47 offen offset:3072 lds
    s_waitcnt lgkmcnt(4)
    v_mfma_f32_32x32x16_bf16 v[136:151], v[176:179], v[60:63], v[136:151]
    ds_read_b64_tr_b16 v[192:193], v12 offset:22528
    ds_read_b64_tr_b16 v[194:195], v12 offset:23040
    v_mfma_f32_32x32x16_bf16 v[152:167], v[180:183], v[60:63], v[152:167]
    ds_read_b64_tr_b16 v[196:197], v13 offset:22528
    ds_read_b64_tr_b16 v[198:199], v13 offset:23040
    s_waitcnt lgkmcnt(4)
    v_mfma_f32_32x32x16_bf16 v[136:151], v[184:187], v[64:67], v[136:151]
    s_waitcnt vmcnt(12) lgkmcnt(0)
    s_barrier
    ds_read_b128 v[72:75], v8 offset:0
    ds_read_b128 v[76:79], v9 offset:0
    ds_read_b128 v[80:83], v10 offset:0
    ds_read_b128 v[84:87], v11 offset:0
    v_mfma_f32_32x32x16_bf16 v[152:167], v[188:191], v[64:67], v[152:167]
    ds_read_b64_tr_b16 v[168:169], v12 offset:24576
    ds_read_b64_tr_b16 v[170:171], v12 offset:25088
    ds_read_b64_tr_b16 v[172:173], v13 offset:24576
    ds_read_b64_tr_b16 v[174:175], v13 offset:25088
    s_add_u32 m0, s57, 16384
    s_nop 0
    buffer_load_dwordx4 v6, s[8:11], s55 offen offset:0 lds
    buffer_load_dwordx4 v7, s[8:11], s55 offen offset:1024 lds
    s_waitcnt lgkmcnt(4)
    v_mfma_f32_32x32x16_bf16 v[136:151], v[192:195], v[68:71], v[136:151]
    ds_read_b64_tr_b16 v[176:177], v12 offset:26624
    ds_read_b64_tr_b16 v[178:179], v12 offset:27136
    v_mfma_f32_32x32x16_bf16 v[152:167], v[196:199], v[68:71], v[152:167]
    ds_read_b64_tr_b16 v[180:181], v13 offset:26624
    ds_read_b64_tr_b16 v[182:183], v13 offset:27136
    s_add_u32 m0, s56, 0
    s_nop 0
    buffer_load_dwordx4 v2, s[4:7], s48 offen offset:0 lds
    buffer_load_dwordx4 v3, s[4:7], s48 offen offset:1024 lds
    s_waitcnt lgkmcnt(4)
    v_mfma_f32_32x32x16_bf16 v[136:151], v[168:171], v[72:75], v[136:151]
    ds_read_b64_tr_b16 v[184:185], v12 offset:28672
    ds_read_b64_tr_b16 v[186:187], v12 offset:29184
    v_mfma_f32_32x32x16_bf16 v[152:167], v[172:175], v[72:75], v[152:167]
    ds_read_b64_tr_b16 v[188:189], v13 offset:28672
    ds_read_b64_tr_b16 v[190:191], v13 offset:29184
    buffer_load_dwordx4 v4, s[4:7], s48 offen offset:2048 lds
    buffer_load_dwordx4 v5, s[4:7], s48 offen offset:3072 lds
    s_waitcnt lgkmcnt(4)
    v_mfma_f32_32x32x16_bf16 v[136:151], v[176:179], v[76:79], v[136:151]
    ds_read_b64_tr_b16 v[192:193], v12 offset:30720
    ds_read_b64_tr_b16 v[194:195], v12 offset:31232
    v_mfma_f32_32x32x16_bf16 v[152:167], v[180:183], v[76:79], v[152:167]
    ds_read_b64_tr_b16 v[196:197], v13 offset:30720
    ds_read_b64_tr_b16 v[198:199], v13 offset:31232
    s_waitcnt lgkmcnt(4)
    v_mfma_f32_32x32x16_bf16 v[136:151], v[184:187], v[80:83], v[136:151]
    s_waitcnt vmcnt(12) lgkmcnt(0)
    s_barrier
    ds_read_b128 v[88:91], v8 offset:16384
    ds_read_b128 v[92:95], v9 offset:16384
    ds_read_b128 v[96:99], v10 offset:16384
    ds_read_b128 v[100:103], v11 offset:16384
    v_mfma_f32_32x32x16_bf16 v[152:167], v[188:191], v[80:83], v[152:167]
    ds_read_b64_tr_b16 v[168:169], v12 offset:0
    ds_read_b64_tr_b16 v[170:171], v12 offset:512
    ds_read_b64_tr_b16 v[172:173], v13 offset:0
    ds_read_b64_tr_b16 v[174:175], v13 offset:512
    s_waitcnt lgkmcnt(4)
    v_mfma_f32_32x32x16_bf16 v[136:151], v[192:195], v[84:87], v[136:151]
    ds_read_b64_tr_b16 v[176:177], v12 offset:2048
    ds_read_b64_tr_b16 v[178:179], v12 offset:2560
    v_mfma_f32_32x32x16_bf16 v[152:167], v[196:199], v[84:87], v[152:167]
    ds_read_b64_tr_b16 v[180:181], v13 offset:2048
    ds_read_b64_tr_b16 v[182:183], v13 offset:2560
    s_add_u32 m0, s56, 16384
    s_add_u32 s49, s49, s65
    buffer_load_dwordx4 v14, s[8:11], s49 offen lds
    s_add_u32 m0, s56, 17408
    s_add_u32 s50, s50, s65
    buffer_load_dwordx4 v14, s[8:11], s50 offen lds
    s_waitcnt lgkmcnt(4)
    v_mfma_f32_32x32x16_bf16 v[136:151], v[168:171], v[88:91], v[136:151]
    ds_read_b64_tr_b16 v[184:185], v12 offset:4096
    ds_read_b64_tr_b16 v[186:187], v12 offset:4608
    v_mfma_f32_32x32x16_bf16 v[152:167], v[172:175], v[88:91], v[152:167]
    ds_read_b64_tr_b16 v[188:189], v13 offset:4096
    ds_read_b64_tr_b16 v[190:191], v13 offset:4608
    s_add_u32 m0, s56, 18432
    s_add_u32 s51, s51, s65
    buffer_load_dwordx4 v14, s[8:11], s51 offen lds
    s_waitcnt lgkmcnt(4)
    v_mfma_f32_32x32x16_bf16 v[136:151], v[176:179], v[92:95], v[136:151]
    ds_read_b64_tr_b16 v[192:193], v12 offset:6144
    ds_read_b64_tr_b16 v[194:195], v12 offset:6656
    v_mfma_f32_32x32x16_bf16 v[152:167], v[180:183], v[92:95], v[152:167]
    ds_read_b64_tr_b16 v[196:197], v13 offset:6144
    ds_read_b64_tr_b16 v[198:199], v13 offset:6656
    s_add_u32 m0, s56, 19456
    s_add_u32 s52, s52, s65
    buffer_load_dwordx4 v14, s[8:11], s52 offen lds
    s_waitcnt lgkmcnt(4)
    v_mfma_f32_32x32x16_bf16 v[136:151], v[184:187], v[96:99], v[136:151]
    s_waitcnt vmcnt(10) lgkmcnt(0)
    s_barrier
    ds_read_b128 v[104:107], v8 offset:32768
    ds_read_b128 v[108:111], v9 offset:32768
    ds_read_b128 v[112:115], v10 offset:32768
    ds_read_b128 v[116:119], v11 offset:32768
    v_mfma_f32_32x32x16_bf16 v[152:167], v[188:191], v[96:99], v[152:167]
    ds_read_b64_tr_b16 v[168:169], v12 offset:8192
    ds_read_b64_tr_b16 v[170:171], v12 offset:8704
    ds_read_b64_tr_b16 v[172:173], v13 offset:8192
    ds_read_b64_tr_b16 v[174:175], v13 offset:8704
    s_waitcnt lgkmcnt(8)
    v_mfma_f32_32x32x16_bf16 v[136:151], v[192:195], v[100:103], v[136:151]
    ds_read_b64_tr_b16 v[176:177], v12 offset:10240
    ds_read_b64_tr_b16 v[178:179], v12 offset:10752
    v_mfma_f32_32x32x16_bf16 v[152:167], v[196:199], v[100:103], v[152:167]
    ds_read_b64_tr_b16 v[180:181], v13 offset:10240
    ds_read_b64_tr_b16 v[182:183], v13 offset:10752
    s_waitcnt lgkmcnt(4)
    v_mfma_f32_32x32x16_bf16 v[136:151], v[168:171], v[104:107], v[136:151]
    ds_read_b64_tr_b16 v[184:185], v12 offset:12288
    ds_read_b64_tr_b16 v[186:187], v12 offset:12800
    v_mfma_f32_32x32x16_bf16 v[152:167], v[172:175], v[104:107], v[152:167]
    ds_read_b64_tr_b16 v[188:189], v13 offset:12288
    ds_read_b64_tr_b16 v[190:191], v13 offset:12800
    s_waitcnt lgkmcnt(4)
    v_mfma_f32_32x32x16_bf16 v[136:151], v[176:179], v[108:111], v[136:151]
    ds_read_b64_tr_b16 v[192:193], v12 offset:14336
    ds_read_b64_tr_b16 v[194:195], v12 offset:14848
    v_mfma_f32_32x32x16_bf16 v[152:167], v[180:183], v[108:111], v[152:167]
    ds_read_b64_tr_b16 v[196:197], v13 offset:14336
    ds_read_b64_tr_b16 v[198:199], v13 offset:14848
    s_waitcnt lgkmcnt(4)
    v_mfma_f32_32x32x16_bf16 v[136:151], v[184:187], v[112:115], v[136:151]
    s_waitcnt vmcnt(4) lgkmcnt(0)
    s_barrier
    ds_read_b128 v[120:123], v8 offset:0
    ds_read_b128 v[124:127], v9 offset:0
    ds_read_b128 v[128:131], v10 offset:0
    ds_read_b128 v[132:135], v11 offset:0
    v_mfma_f32_32x32x16_bf16 v[152:167], v[188:191], v[112:115], v[152:167]
    ds_read_b64_tr_b16 v[168:169], v12 offset:16384
    ds_read_b64_tr_b16 v[170:171], v12 offset:16896
    ds_read_b64_tr_b16 v[172:173], v13 offset:16384
    ds_read_b64_tr_b16 v[174:175], v13 offset:16896
    s_waitcnt lgkmcnt(8)
    v_mfma_f32_32x32x16_bf16 v[136:151], v[192:195], v[116:119], v[136:151]
    ds_read_b64_tr_b16 v[176:177], v12 offset:18432
    ds_read_b64_tr_b16 v[178:179], v12 offset:18944
    v_mfma_f32_32x32x16_bf16 v[152:167], v[196:199], v[116:119], v[152:167]
    ds_read_b64_tr_b16 v[180:181], v13 offset:18432
    ds_read_b64_tr_b16 v[182:183], v13 offset:18944
    s_waitcnt lgkmcnt(4)
    v_mfma_f32_32x32x16_bf16 v[136:151], v[168:171], v[120:123], v[136:151]
    ds_read_b64_tr_b16 v[184:185], v12 offset:20480
    ds_read_b64_tr_b16 v[186:187], v12 offset:20992
    v_mfma_f32_32x32x16_bf16 v[152:167], v[172:175], v[120:123], v[152:167]
    ds_read_b64_tr_b16 v[188:189], v13 offset:20480
    ds_read_b64_tr_b16 v[190:191], v13 offset:20992
    s_waitcnt lgkmcnt(4)
    v_mfma_f32_32x32x16_bf16 v[136:151], v[176:179], v[124:127], v[136:151]
    ds_read_b64_tr_b16 v[192:193], v12 offset:22528
    ds_read_b64_tr_b16 v[194:195], v12 offset:23040
    v_mfma_f32_32x32x16_bf16 v[152:167], v[180:183], v[124:127], v[152:167]
    ds_read_b64_tr_b16 v[196:197], v13 offset:22528
    ds_read_b64_tr_b16 v[198:199], v13 offset:23040
    s_waitcnt lgkmcnt(4)
    v_mfma_f32_32x32x16_bf16 v[136:151], v[184:187], v[128:131], v[136:151]
    v_mfma_f32_32x32x16_bf16 v[152:167], v[188:191], v[128:131], v[152:167]
    s_waitcnt lgkmcnt(0)
    v_mfma_f32_32x32x16_bf16 v[136:151], v[192:195], v[132:135], v[136:151]
    v_mfma_f32_32x32x16_bf16 v[152:167], v[196:199], v[132:135], v[152:167]
    s_setprio 3
    s_nop 9
    v_cvt_pk_bf16_f32 v168, v136, v137
    v_cvt_pk_bf16_f32 v169, v138, v139
    v_cvt_pk_bf16_f32 v170, v140, v141
    v_cvt_pk_bf16_f32 v171, v142, v143
    buffer_store_dwordx4 v[168:171], v16, s[12:15], s61 offen offset:0 sc1
    v_cvt_pk_bf16_f32 v172, v144, v145
    v_cvt_pk_bf16_f32 v173, v146, v147
    v_cvt_pk_bf16_f32 v174, v148, v149
    v_cvt_pk_bf16_f32 v175, v150, v151
    buffer_store_dwordx4 v[172:175], v16, s[12:15], s61 offen offset:1024 sc1
    v_cvt_pk_bf16_f32 v176, v152, v153
    v_cvt_pk_bf16_f32 v177, v154, v155
    v_cvt_pk_bf16_f32 v178, v156, v157
    v_cvt_pk_bf16_f32 v179, v158, v159
    buffer_store_dwordx4 v[176:179], v16, s[12:15], s61 offen offset:2048 sc1
    v_cvt_pk_bf16_f32 v180, v160, v161
    v_cvt_pk_bf16_f32 v181, v162, v163
    v_cvt_pk_bf16_f32 v182, v164, v165
    v_cvt_pk_bf16_f32 v183, v166, v167
    buffer_store_dwordx4 v[180:183], v16, s[12:15], s61 offen offset:3072 sc1
    s_add_u32 m0, s56, 32768
    s_add_u32 s53, s53, s65
    buffer_load_dwordx4 v14, s[8:11], s53 offen lds
    s_add_u32 m0, s56, 33792
    s_add_u32 s54, s54, s65
    buffer_load_dwordx4 v14, s[8:11], s54 offen lds
    s_add_u32 m0, s56, 34816
    s_add_u32 s55, s55, s65
    buffer_load_dwordx4 v14, s[8:11], s55 offen lds
    s_branch L_pg_B2
.p2align 12
L_stub_B1V:
L_pg_B1V:
    s_add_u32 m0, s57, 8192
    s_nop 0
    buffer_load_dwordx4 v6, s[8:11], s50 offen offset:0 lds
    buffer_load_dwordx4 v7, s[8:11], s50 offen offset:1024 lds
    s_add_u32 m0, s56, 16384
    s_nop 0
    buffer_load_dwordx4 v2, s[4:7], s43 offen offset:0 lds
    buffer_load_dwordx4 v3, s[4:7], s43 offen offset:1024 lds
    buffer_load_dwordx4 v4, s[4:7], s43 offen offset:2048 lds
    buffer_load_dwordx4 v5, s[4:7], s43 offen offset:3072 lds
    s_add_u32 m0, s57, 16384
    s_nop 0
    buffer_load_dwordx4 v6, s[8:11], s51 offen offset:0 lds
    buffer_load_dwordx4 v7, s[8:11], s51 offen offset:1024 lds
    s_add_u32 m0, s56, 32768
    s_nop 0
    buffer_load_dwordx4 v2, s[4:7], s44 offen offset:0 lds
    buffer_load_dwordx4 v3, s[4:7], s44 offen offset:1024 lds
    buffer_load_dwordx4 v4, s[4:7], s44 offen offset:2048 lds
    buffer_load_dwordx4 v5, s[4:7], s44 offen offset:3072 lds
    s_waitcnt vmcnt(12) lgkmcnt(0)
    s_barrier
    ds_read_b128 v[24:27], v8 offset:0
    ds_read_b64_tr_b16 v[168:169], v12 offset:0
    ds_read_b64_tr_b16 v[170:171], v12 offset:512
    ds_read_b64_tr_b16 v[172:173], v13 offset:0
    ds_read_b64_tr_b16 v[174:175], v13 offset:512
    ds_read_b128 v[28:31], v9 offset:0
    ds_read_b128 v[32:35], v10 offset:0
    ds_read_b128 v[36:39], v11 offset:0
    ds_read_b64_tr_b16 v[176:177], v12 offset:2048
    ds_read_b64_tr_b16 v[178:179], v12 offset:2560
    ds_read_b64_tr_b16 v[180:181], v13 offset:2048
    ds_read_b64_tr_b16 v[182:183], v13 offset:2560
    s_add_u32 m0, s57, 24576
    s_nop 0
    buffer_load_dwordx4 v6, s[8:11], s52 offen offset:0 lds
    buffer_load_dwordx4 v7, s[8:11], s52 offen offset:1024 lds
    s_add_u32 s41, s41, 0x9e3779b9
    s_mov_b32 s12, s28
    s_mov_b32 s13, s29
    s_mov_b32 s14, 10485760
    s_mov_b32 s15, 0x00020000
    s_add_u32 s20, s12, s18
    s_addc_u32 s21, s13, 0
    s_mov_b32 s22, 28672
    s_mov_b32 s23, 0x00020000
    s_add_u32 s24, s12, 14336
    s_addc_u32 s25, s13, 0
    s_mov_b32 s26, 10471424
    s_mov_b32 s27, 0x00020000
    s_waitcnt lgkmcnt(4)
    v_mfma_f32_32x32x16_bf16 v[136:151], v[24:27], v[168:171], 0
    ds_read_b64_tr_b16 v[184:185], v12 offset:4096
    ds_read_b64_tr_b16 v[186:187], v12 offset:4608
    v_mfma_f32_32x32x16_bf16 v[152:167], v[24:27], v[172:175], 0
    ds_read_b64_tr_b16 v[188:189], v13 offset:4096
    ds_read_b64_tr_b16 v[190:191], v13 offset:4608
    s_add_u32 m0, s56, 0
    s_nop 0
    buffer_load_dwordx4 v2, s[4:7], s45 offen offset:0 lds
    buffer_load_dwordx4 v3, s[4:7], s45 offen offset:1024 lds
    s_waitcnt lgkmcnt(4)
    v_mfma_f32_32x32x16_bf16 v[136:151], v[28:31], v[176:179], v[136:151]
    ds_read_b64_tr_b16 v[192:193], v12 offset:6144
    ds_read_b64_tr_b16 v[194:195], v12 offset:6656
    v_mfma_f32_32x32x16_bf16 v[152:167], v[28:31], v[180:183], v[152:167]
    ds_read_b64_tr_b16 v[196:197], v13 offset:6144
    ds_read_b64_tr_b16 v[198:199], v13 offset:6656
    buffer_load_dwordx4 v4, s[4:7], s45 offen offset:2048 lds
    buffer_load_dwordx4 v5, s[4:7], s45 offen offset:3072 lds
    s_waitcnt lgkmcnt(4)
    v_mfma_f32_32x32x16_bf16 v[136:151], v[32:35], v[184:187], v[136:151]
    s_waitcnt vmcnt(12) lgkmcnt(0)
    s_barrier
    ds_read_b128 v[40:43], v8 offset:16384
    ds_read_b128 v[44:47], v9 offset:16384
    ds_read_b128 v[48:51], v10 offset:16384
    ds_read_b128 v[52:55], v11 offset:16384
    v_mfma_f32_32x32x16_bf16 v[152:167], v[32:35], v[188:191], v[152:167]
    ds_read_b64_tr_b16 v[168:169], v12 offset:8192
    ds_read_b64_tr_b16 v[170:171], v12 offset:8704
    ds_read_b64_tr_b16 v[172:173], v13 offset:8192
    ds_read_b64_tr_b16 v[174:175], v13 offset:8704
    s_add_u32 m0, s57, 0
    s_nop 0
    buffer_load_dwordx4 v6, s[8:11], s53 offen offset:0 lds
    buffer_load_dwordx4 v7, s[8:11], s53 offen offset:1024 lds
    s_waitcnt lgkmcnt(4)
    v_mfma_f32_32x32x16_bf16 v[136:151], v[36:39], v[192:195], v[136:151]
    ds_read_b64_tr_b16 v[176:177], v12 offset:10240
    ds_read_b64_tr_b16 v[178:179], v12 offset:10752
    v_mfma_f32_32x32x16_bf16 v[152:167], v[36:39], v[196:199], v[152:167]
    ds_read_b64_tr_b16 v[180:181], v13 offset:10240
    ds_read_b64_tr_b16 v[182:183], v13 offset:10752
    s_add_u32 m0, s56, 16384
    s_nop 0
    buffer_load_dwordx4 v2, s[4:7], s46 offen offset:0 lds
    buffer_load_dwordx4 v3, s[4:7], s46 offen offset:1024 lds
    s_waitcnt lgkmcnt(4)
    v_mfma_f32_32x32x16_bf16 v[136:151], v[40:43], v[168:171], v[136:151]
    ds_read_b64_tr_b16 v[184:185], v12 offset:12288
    ds_read_b64_tr_b16 v[186:187], v12 offset:12800
    v_mfma_f32_32x32x16_bf16 v[152:167], v[40:43], v[172:175], v[152:167]
    ds_read_b64_tr_b16 v[188:189], v13 offset:12288
    ds_read_b64_tr_b16 v[190:191], v13 offset:12800
    buffer_load_dwordx4 v4, s[4:7], s46 offen offset:2048 lds
    buffer_load_dwordx4 v5, s[4:7], s46 offen offset:3072 lds
    s_waitcnt lgkmcnt(4)
    v_mfma_f32_32x32x16_bf16 v[136:151], v[44:47], v[176:179], v[136:151]
    ds_read_b64_tr_b16 v[192:193], v12 offset:14336
    ds_read_b64_tr_b16 v[194:195], v12 offset:14848
    v_mfma_f32_32x32x16_bf16 v[152:167], v[44:47], v[180:183], v[152:167]
    ds_read_b64_tr_b16 v[196:197], v13 offset:14336
    ds_read_b64_tr_b16 v[198:199], v13 offset:14848
    s_waitcnt lgkmcnt(4)
    v_mfma_f32_32x32x16_bf16 v[136:151], v[48:51], v[184:187], v[136:151]
    s_waitcnt vmcnt(12) lgkmcnt(0)
    s_barrier
    ds_read_b128 v[56:59], v8 offset:32768
    ds_read_b128 v[60:63], v9 offset:32768
    ds_read_b128 v[64:67], v10 offset:32768
    ds_read_b128 v[68:71], v11 offset:32768
    v_mfma_f32_32x32x16_bf16 v[152:167], v[48:51], v[188:191], v[152:167]
    ds_read_b64_tr_b16 v[168:169], v12 offset:16384
    ds_read_b64_tr_b16 v[170:171], v12 offset:16896
    ds_read_b64_tr_b16 v[172:173], v13 offset:16384
    ds_read_b64_tr_b16 v[174:175], v13 offset:16896
    s_add_u32 m0, s57, 8192
    s_nop 0
    buffer_load_dwordx4 v6, s[8:11], s54 offen offset:0 lds
    buffer_load_dwordx4 v7, s[8:11], s54 offen offset:1024 lds
    s_waitcnt lgkmcnt(4)
    v_mfma_f32_32x32x16_bf16 v[136:151], v[52:55], v[192:195], v[136:151]
    ds_read_b64_tr_b16 v[176:177], v12 offset:18432
    ds_read_b64_tr_b16 v[178:179], v12 offset:18944
    v_mfma_f32_32x32x16_bf16 v[152:167], v[52:55], v[196:199], v[152:167]
    ds_read_b64_tr_b16 v[180:181], v13 offset:18432
    ds_read_b64_tr_b16 v[182:183], v13 offset:18944
    s_add_u32 m0, s56, 32768
    s_nop 0
    buffer_load_dwordx4 v2, s[4:7], s47 offen offset:0 lds
    buffer_load_dwordx4 v3, s[4:7], s47 offen offset:1024 lds
    s_waitcnt lgkmcnt(4)
    v_mfma_f32_32x32x16_bf16 v[136:151], v[56:59], v[168:171], v[136:151]
    ds_read_b64_tr_b16 v[184:185], v12 offset:20480
    ds_read_b64_tr_b16 v[186:187], v12 offset:20992
    v_mfma_f32_32x32x16_bf16 v[152:167], v[56:59], v[172:175], v[152:167]
    ds_read_b64_tr_b16 v[188:189], v13 offset:20480
    ds_read_b64_tr_b16 v[190:191], v13 offset:20992
    buffer_load_dwordx4 v4, s[4:7], s47 offen offset:2048 lds
    buffer_load_dwordx4 v5, s[4:7], s47 offen offset:3072 lds
    s_waitcnt lgkmcnt(4)
    v_mfma_f32_32x32x16_bf16 v[136:151], v[60:63], v[176:179], v[136:151]
    ds_read_b64_tr_b16 v[192:193], v12 offset:22528
    ds_read_b64_tr_b16 v[194:195], v12 offset:23040
    v_mfma_f32_32x32x16_bf16 v[152:167], v[60:63], v[180:183], v[152:167]
    ds_read_b64_tr_b16 v[196:197], v13 offset:22528
    ds_read_b64_tr_b16 v[198:199], v13 offset:23040
    s_waitcnt lgkmcnt(4)
    v_mfma_f32_32x32x16_bf16 v[136:151], v[64:67], v[184:187], v[136:151]
    s_waitcnt vmcnt(12) lgkmcnt(0)
    s_barrier
    ds_read_b128 v[72:75], v8 offset:0
    ds_read_b128 v[76:79], v9 offset:0
    ds_read_b128 v[80:83], v10 offset:0
    ds_read_b128 v[84:87], v11 offset:0
    v_mfma_f32_32x32x16_bf16 v[152:167], v[64:67], v[188:191], v[152:167]
    ds_read_b64_tr_b16 v[168:169], v12 offset:24576
    ds_read_b64_tr_b16 v[170:171], v12 offset:25088
    ds_read_b64_tr_b16 v[172:173], v13 offset:24576
    ds_read_b64_tr_b16 v[174:175], v13 offset:25088
    s_add_u32 m0, s57, 16384
    s_nop 0
    buffer_load_dwordx4 v6, s[8:11], s55 offen offset:0 lds
    buffer_load_dwordx4 v7, s[8:11], s55 offen offset:1024 lds
    s_waitcnt lgkmcnt(4)
    v_mfma_f32_32x32x16_bf16 v[136:151], v[68:71], v[192:195], v[136:151]
    ds_read_b64_tr_b16 v[176:177], v12 offset:26624
    ds_read_b64_tr_b16 v[178:179], v12 offset:27136
    v_mfma_f32_32x32x16_bf16 v[152:167], v[68:71], v[196:199], v[152:167]
    ds_read_b64_tr_b16 v[180:181], v13 offset:26624
    ds_read_b64_tr_b16 v[182:183], v13 offset:27136
    s_add_u32 m0, s56, 0
    s_nop 0
    buffer_load_dwordx4 v2, s[4:7], s48 offen offset:0 lds
    buffer_load_dwordx4 v3, s[4:7], s48 offen offset:1024 lds
    s_waitcnt lgkmcnt(4)
    v_mfma_f32_32x32x16_bf16 v[136:151], v[72:75], v[168:171], v[136:151]
    ds_read_b64_tr_b16 v[184:185], v12 offset:28672
    ds_read_b64_tr_b16 v[186:187], v12 offset:29184
    v_mfma_f32_32x32x16_bf16 v[152:167], v[72:75], v[172:175], v[152:167]
    ds_read_b64_tr_b16 v[188:189], v13 offset:28672
    ds_read_b64_tr_b16 v[190:191], v13 offset:29184
    buffer_load_dwordx4 v4, s[4:7], s48 offen offset:2048 lds
    buffer_load_dwordx4 v5, s[4:7], s48 offen offset:3072 lds
    s_waitcnt lgkmcnt(4)
    v_mfma_f32_32x32x16_bf16 v[136:151], v[76:79], v[176:179], v[136:151]
    ds_read_b64_tr_b16 v[192:193], v12 offset:30720
    ds_read_b64_tr_b16 v[194:195], v12 offset:31232
    v_mfma_f32_32x32x16_bf16 v[152:167], v[76:79], v[180:183], v[152:167]
    ds_read_b64_tr_b16 v[196:197], v13 offset:30720
    ds_read_b64_tr_b16 v[198:199], v13 offset:31232
    s_waitcnt lgkmcnt(4)
    v_mfma_f32_32x32x16_bf16 v[136:151], v[80:83], v[184:187], v[136:151]
    s_waitcnt vmcnt(12) lgkmcnt(0)
    s_barrier
    ds_read_b128 v[88:91], v8 offset:16384
    ds_read_b128 v[92:95], v9 offset:16384
    ds_read_b128 v[96:99], v10 offset:16384
    ds_read_b128 v[100:103], v11 offset:16384
    v_mfma_f32_32x32x16_bf16 v[152:167], v[80:83], v[188:191], v[152:167]
    ds_read_b64_tr_b16 v[168:169], v12 offset:0
    ds_read_b64_tr_b16 v[170:171], v12 offset:512
    ds_read_b64_tr_b16 v[172:173], v13 offset:0
    ds_read_b64_tr_b16 v[174:175], v13 offset:512
    s_waitcnt lgkmcnt(4)
    v_mfma_f32_32x32x16_bf16 v[136:151], v[84:87], v[192:195], v[136:151]
    ds_read_b64_tr_b16 v[176:177], v12 offset:2048
    ds_read_b64_tr_b16 v[178:179], v12 offset:2560
    v_mfma_f32_32x32x16_bf16 v[152:167], v[84:87], v[196:199], v[152:167]
    ds_read_b64_tr_b16 v[180:181], v13 offset:2048
    ds_read_b64_tr_b16 v[182:183], v13 offset:2560
    s_add_u32 m0, s56, 16384
    s_add_u32 s49, s49, s65
    buffer_load_dwordx4 v14, s[8:11], s49 offen lds
    s_add_u32 m0, s56, 17408
    s_add_u32 s50, s50, s65
    buffer_load_dwordx4 v14, s[8:11], s50 offen lds
    s_waitcnt lgkmcnt(4)
    v_mfma_f32_32x32x16_bf16 v[136:151], v[88:91], v[168:171], v[136:151]
    ds_read_b64_tr_b16 v[184:185], v12 offset:4096
    ds_read_b64_tr_b16 v[186:187], v12 offset:4608
    v_mfma_f32_32x32x16_bf16 v[152:167], v[88:91], v[172:175], v[152:167]
    ds_read_b64_tr_b16 v[188:189], v13 offset:4096
    ds_read_b64_tr_b16 v[190:191], v13 offset:4608
    s_add_u32 m0, s56, 18432
    s_add_u32 s51, s51, s65
    buffer_load_dwordx4 v14, s[8:11], s51 offen lds
    s_waitcnt lgkmcnt(4)
    v_mfma_f32_32x32x16_bf16 v[136:151], v[92:95], v[176:179], v[136:151]
    ds_read_b64_tr_b16 v[192:193], v12 offset:6144
    ds_read_b64_tr_b16 v[194:195], v12 offset:6656
    v_mfma_f32_32x32x16_bf16 v[152:167], v[92:95], v[180:183], v[152:167]
    ds_read_b64_tr_b16 v[196:197], v13 offset:6144
    ds_read_b64_tr_b16 v[198:199], v13 offset:6656
    s_add_u32 m0, s56, 19456
    s_add_u32 s52, s52, s65
    buffer_load_dwordx4 v14, s[8:11], s52 offen lds
    s_waitcnt lgkmcnt(4)
    v_mfma_f32_32x32x16_bf16 v[136:151], v[96:99], v[184:187], v[136:151]
    s_waitcnt vmcnt(10) lgkmcnt(0)
    s_barrier
    ds_read_b128 v[104:107], v8 offset:32768
    ds_read_b128 v[108:111], v9 offset:32768
    ds_read_b128 v[112:115], v10 offset:32768
    ds_read_b128 v[116:119], v11 offset:32768
    v_mfma_f32_32x32x16_bf16 v[152:167], v[96:99], v[188:191], v[152:167]
    ds_read_b64_tr_b16 v[168:169], v12 offset:8192
    ds_read_b64_tr_b16 v[170:171], v12 offset:8704
    ds_read_b64_tr_b16 v[172:173], v13 offset:8192
    ds_read_b64_tr_b16 v[174:175], v13 offset:8704
    s_waitcnt lgkmcnt(8)
    v_mfma_f32_32x32x16_bf16 v[136:151], v[100:103], v[192:195], v[136:151]
    ds_read_b64_tr_b16 v[176:177], v12 offset:10240
    ds_read_b64_tr_b16 v[178:179], v12 offset:10752
    v_mfma_f32_32x32x16_bf16 v[152:167], v[100:103], v[196:199], v[152:167]
    ds_read_b64_tr_b16 v[180:181], v13 offset:10240
    ds_read_b64_tr_b16 v[182:183], v13 offset:10752
    s_waitcnt lgkmcnt(4)
    v_mfma_f32_32x32x16_bf16 v[136:151], v[104:107], v[168:171], v[136:151]
    ds_read_b64_tr_b16 v[184:185], v12 offset:12288
    ds_read_b64_tr_b16 v[186:187], v12 offset:12800
    v_mfma_f32_32x32x16_bf16 v[152:167], v[104:107], v[172:175], v[152:167]
    ds_read_b64_tr_b16 v[188:189], v13 offset:12288
    ds_read_b64_tr_b16 v[190:191], v13 offset:12800
    s_waitcnt lgkmcnt(4)
    v_mfma_f32_32x32x16_bf16 v[136:151], v[108:111], v[176:179], v[136:151]
    ds_read_b64_tr_b16 v[192:193], v12 offset:14336
    ds_read_b64_tr_b16 v[194:195], v12 offset:14848
    v_mfma_f32_32x32x16_bf16 v[152:167], v[108:111], v[180:183], v[152:167]
    ds_read_b64_tr_b16 v[196:197], v13 offset:14336
    ds_read_b64_tr_b16 v[198:199], v13 offset:14848
    s_waitcnt lgkmcnt(4)
    v_mfma_f32_32x32x16_bf16 v[136:151], v[112:115], v[184:187], v[136:151]
    s_waitcnt vmcnt(4) lgkmcnt(0)
    s_barrier
    ds_read_b128 v[120:123], v8 offset:0
    ds_read_b128 v[124:127], v9 offset:0
    ds_read_b128 v[128:131], v10 offset:0
    ds_read_b128 v[132:135], v11 offset:0
    v_mfma_f32_32x32x16_bf16 v[152:167], v[112:115], v[188:191], v[152:167]
    ds_read_b64_tr_b16 v[168:169], v12 offset:16384
    ds_read_b64_tr_b16 v[170:171], v12 offset:16896
    ds_read_b64_tr_b16 v[172:173], v13 offset:16384
    ds_read_b64_tr_b16 v[174:175], v13 offset:16896
    s_waitcnt lgkmcnt(8)
    v_mfma_f32_32x32x16_bf16 v[136:151], v[116:119], v[192:195], v[136:151]
    ds_read_b64_tr_b16 v[176:177], v12 offset:18432
    ds_read_b64_tr_b16 v[178:179], v12 offset:18944
    v_mfma_f32_32x32x16_bf16 v[152:167], v[116:119], v[196:199], v[152:167]
    ds_read_b64_tr_b16 v[180:181], v13 offset:18432
    ds_read_b64_tr_b16 v[182:183], v13 offset:18944
    s_waitcnt lgkmcnt(4)
    v_mfma_f32_32x32x16_bf16 v[136:151], v[120:123], v[168:171], v[136:151]
    ds_read_b64_tr_b16 v[184:185], v12 offset:20480
    ds_read_b64_tr_b16 v[186:187], v12 offset:20992
    v_mfma_f32_32x32x16_bf16 v[152:167], v[120:123], v[172:175], v[152:167]
    ds_read_b64_tr_b16 v[188:189], v13 offset:20480
    ds_read_b64_tr_b16 v[190:191], v13 offset:20992
    s_waitcnt lgkmcnt(4)
    v_mfma_f32_32x32x16_bf16 v[136:151], v[124:127], v[176:179], v[136:151]
    ds_read_b64_tr_b16 v[192:193], v12 offset:22528
    ds_read_b64_tr_b16 v[194:195], v12 offset:23040
    v_mfma_f32_32x32x16_bf16 v[152:167], v[124:127], v[180:183], v[152:167]
    ds_read_b64_tr_b16 v[196:197], v13 offset:22528
    ds_read_b64_tr_b16 v[198:199], v13 offset:23040
    s_waitcnt lgkmcnt(4)
    v_mfma_f32_32x32x16_bf16 v[136:151], v[128:131], v[184:187], v[136:151]
    v_mfma_f32_32x32x16_bf16 v[152:167], v[128:131], v[188:191], v[152:167]
    s_waitcnt lgkmcnt(0)
    v_mfma_f32_32x32x16_bf16 v[136:151], v[132:135], v[192:195], v[136:151]
    v_mfma_f32_32x32x16_bf16 v[152:167], v[132:135], v[196:199], v[152:167]
    s_setprio 3
    s_nop 9
    v_cvt_pk_bf16_f32 v168, v136, v137
    v_cvt_pk_bf16_f32 v169, v138, v139
    v_cvt_pk_bf16_f32 v170, v140, v141
    v_cvt_pk_bf16_f32 v171, v142, v143
    buffer_store_dwordx4 v[168:171], v16, s[12:15], s61 offen offset:0 sc1
    v_cvt_pk_bf16_f32 v172, v144, v145
    v_cvt_pk_bf16_f32 v173, v146, v147
    v_cvt_pk_bf16_f32 v174, v148, v149
    v_cvt_pk_bf16_f32 v175, v150, v151
    buffer_store_dwordx4 v[172:175], v16, s[12:15], s62 offen offset:0 sc1
    v_cvt_pk_bf16_f32 v176, v152, v153
    v_cvt_pk_bf16_f32 v177, v154, v155
    v_cvt_pk_bf16_f32 v178, v156, v157
    v_cvt_pk_bf16_f32 v179, v158, v159
    buffer_store_dwordx4 v[176:179], v16, s[12:15], s61 offen offset:512 sc1
    v_cvt_pk_bf16_f32 v180, v160, v161
    v_cvt_pk_bf16_f32 v181, v162, v163
    v_cvt_pk_bf16_f32 v182, v164, v165
    v_cvt_pk_bf16_f32 v183, v166, v167
    buffer_store_dwordx4 v[180:183], v16, s[12:15], s62 offen offset:512 sc1
    s_add_u32 m0, s56, 32768
    s_add_u32 s53, s53, s65
    buffer_load_dwordx4 v14, s[8:11], s53 offen lds
    s_add_u32 m0, s56, 33792
    s_add_u32 s54, s54, s65
    buffer_load_dwordx4 v14, s[8:11], s54 offen lds
    s_add_u32 m0, s56, 34816
    s_add_u32 s55, s55, s65
    buffer_load_dwordx4 v14, s[8:11], s55 offen lds
    s_branch L_pg_B2
.p2align 12
L_stub_B2:
    s_branch L_backB
    s_nop 0
L_pg_B2:
    s_waitcnt vmcnt(7)
    s_barrier
    ds_read_b64_tr_b16 v[136:137], v15 offset:16384
    ds_read_b64_tr_b16 v[138:139], v15 offset:16640
    ds_read_b64_tr_b16 v[140:141], v15 offset:20480
    ds_read_b64_tr_b16 v[142:143], v15 offset:20736
    ds_read_b64_tr_b16 v[144:145], v15 offset:24576
    ds_read_b64_tr_b16 v[146:147], v15 offset:24832
    ds_read_b64_tr_b16 v[148:149], v15 offset:28672
    ds_read_b64_tr_b16 v[150:151], v15 offset:28928
    buffer_store_dwordx4 v[208:211], v203, s[12:15], 0 offen
    v_mov_b32 v6, s41
    v_mov_b32 v5, 0xdddddddd
    s_waitcnt lgkmcnt(6)
    v_mfma_f32_32x32x16_bf16 v[216:231], v[136:139], v[24:27], 0
    ds_read_b64_tr_b16 v[152:153], v15 offset:17408
    ds_read_b64_tr_b16 v[154:155], v15 offset:17664
    s_lshl_b32 s43, s67, 2
    s_waitcnt lgkmcnt(6)
    v_mfma_f32_32x32x16_bf16 v[216:231], v[140:143], v[28:31], v[216:231]
    ds_read_b64_tr_b16 v[156:157], v15 offset:21504
    ds_read_b64_tr_b16 v[158:159], v15 offset:21760
    s_sub_u32 s43, s43, s16
    s_waitcnt lgkmcnt(6)
    v_mfma_f32_32x32x16_bf16 v[216:231], v[144:147], v[32:35], v[216:231]
    ds_read_b64_tr_b16 v[160:161], v15 offset:25600
    ds_read_b64_tr_b16 v[162:163], v15 offset:25856
    s_sub_u32 s43, s43, 1
    s_waitcnt lgkmcnt(6)
    v_mfma_f32_32x32x16_bf16 v[216:231], v[148:151], v[36:39], v[216:231]
    ds_read_b64_tr_b16 v[164:165], v15 offset:29696
    ds_read_b64_tr_b16 v[166:167], v15 offset:29952
    s_mul_i32 s45, s43, 90240
    s_waitcnt lgkmcnt(6)
    v_mfma_f32_32x32x16_bf16 v[216:231], v[152:155], v[40:43], v[216:231]
    ds_read_b64_tr_b16 v[136:137], v15 offset:18432
    ds_read_b64_tr_b16 v[138:139], v15 offset:18688
    s_and_b32 s53, s41, 0xbfff0000
    s_waitcnt lgkmcnt(6)
    v_mfma_f32_32x32x16_bf16 v[216:231], v[156:159], v[44:47], v[216:231]
    ds_read_b64_tr_b16 v[140:141], v15 offset:22528
    ds_read_b64_tr_b16 v[142:143], v15 offset:22784
    s_or_b32 s53, s53, 0x20000000
    s_waitcnt lgkmcnt(6)
    v_mfma_f32_32x32x16_bf16 v[216:231], v[160:163], v[48:51], v[216:231]
    ds_read_b64_tr_b16 v[144:145], v15 offset:26624
    ds_read_b64_tr_b16 v[146:147], v15 offset:26880
    s_mov_b32 s44, 32768
    s_waitcnt lgkmcnt(6)
    v_mfma_f32_32x32x16_bf16 v[216:231], v[164:167], v[52:55], v[216:231]
    ds_read_b64_tr_b16 v[148:149], v15 offset:30720
    ds_read_b64_tr_b16 v[150:151], v15 offset:30976
    s_waitcnt lgkmcnt(6)
    v_mfma_f32_32x32x16_bf16 v[216:231], v[136:139], v[56:59], v[216:231]
    ds_read_b64_tr_b16 v[152:153], v15 offset:19456
    ds_read_b64_tr_b16 v[154:155], v15 offset:19712
    s_waitcnt lgkmcnt(6)
    v_mfma_f32_32x32x16_bf16 v[216:231], v[140:143], v[60:63], v[216:231]
    ds_read_b64_tr_b16 v[156:157], v15 offset:23552
    ds_read_b64_tr_b16 v[158:159], v15 offset:23808
    buffer_load_dword v7, v207, s[12:15], s19 offen sc1
    s_waitcnt lgkmcnt(6)
    v_mfma_f32_32x32x16_bf16 v[216:231], v[144:147], v[64:67], v[216:231]
    ds_read_b64_tr_b16 v[160:161], v15 offset:27648
    ds_read_b64_tr_b16 v[162:163], v15 offset:27904
    s_waitcnt lgkmcnt(6)
    v_mfma_f32_32x32x16_bf16 v[216:231], v[148:151], v[68:71], v[216:231]
    ds_read_b64_tr_b16 v[164:165], v15 offset:31744
    ds_read_b64_tr_b16 v[166:167], v15 offset:32000
    s_waitcnt lgkmcnt(6)
    v_mfma_f32_32x32x16_bf16 v[216:231], v[152:155], v[72:75], v[216:231]
    s_waitcnt lgkmcnt(4)
    v_mfma_f32_32x32x16_bf16 v[216:231], v[156:159], v[76:79], v[216:231]
    s_waitcnt lgkmcnt(2)
    v_mfma_f32_32x32x16_bf16 v[216:231], v[160:163], v[80:83], v[216:231]
    s_waitcnt lgkmcnt(0)
    v_mfma_f32_32x32x16_bf16 v[216:231], v[164:167], v[84:87], v[216:231]
    v_mfma_f32_32x32x16_bf16 v[24:39], v[212:215], v[212:215], 0
    v_mfma_f32_32x32x16_bf16 v[40:55], v[212:215], v[212:215], 0
    v_mfma_f32_32x32x16_bf16 v[56:71], v[212:215], v[212:215], 0
    v_mfma_f32_32x32x16_bf16 v[72:87], v[212:215], v[212:215], 0
    s_waitcnt vmcnt(5)
    s_barrier
    buffer_store_dword v6, v23, s[12:15], 0 offen sc1
    s_waitcnt vmcnt(1)
    v_cmp_ne_u32 s[54:55], s41, v7
    s_barrier
    s_nop 0
    s_cmp_eq_u64 s[54:55], 0
    s_cbranch_scc0 L_notyet
    ds_read_b64_tr_b16 v[136:137], v15 offset:32768
    ds_read_b64_tr_b16 v[138:139], v15 offset:33024
    ds_read_b64_tr_b16 v[140:141], v15 offset:36864
    ds_read_b64_tr_b16 v[142:143], v15 offset:37120
    ds_read_b64_tr_b16 v[144:145], v15 offset:40960
    ds_read_b64_tr_b16 v[146:147], v15 offset:41216
    ds_read_b64_tr_b16 v[148:149], v15 offset:45056
    ds_read_b64_tr_b16 v[150:151], v15 offset:45312
    s_waitcnt lgkmcnt(6)
    v_mfma_f32_32x32x16_bf16 v[216:231], v[136:139], v[88:91], v[216:231]
    ds_read_b64_tr_b16 v[152:153], v15 offset:33792
    ds_read_b64_tr_b16 v[154:155], v15 offset:34048
    buffer_load_dwordx4 v[168:171], v19, s[20:23], 0 offen sc1
    s_waitcnt lgkmcnt(6)
    v_mfma_f32_32x32x16_bf16 v[216:231], v[140:143], v[92:95], v[216:231]
    ds_read_b64_tr_b16 v[156:157], v15 offset:37888
    ds_read_b64_tr_b16 v[158:159], v15 offset:38144
    buffer_load_dwordx4 v[172:175], v19, s[20:23], 0 offen offset:1024 sc1
    s_waitcnt lgkmcnt(6)
    v_mfma_f32_32x32x16_bf16 v[216:231], v[144:147], v[96:99], v[216:231]
    ds_read_b64_tr_b16 v[160:161], v15 offset:41984
    ds_read_b64_tr_b16 v[162:163], v15 offset:42240
    buffer_load_dwordx4 v[176:179], v20, s[12:15], 0 offen sc1
    s_waitcnt lgkmcnt(6)
    v_mfma_f32_32x32x16_bf16 v[216:231], v[148:151], v[100:103], v[216:231]
    ds_read_b64_tr_b16 v[164:165], v15 offset:46080
    ds_read_b64_tr_b16 v[166:167], v15 offset:46336
    buffer_load_dwordx4 v[180:183], v20, s[24:27], 0 offen sc1
    s_waitcnt lgkmcnt(6)
    v_mfma_f32_32x32x16_bf16 v[216:231], v[152:155], v[104:107], v[216:231]
    ds_read_b64_tr_b16 v[136:137], v15 offset:34816
    ds_read_b64_tr_b16 v[138:139], v15 offset:35072
    s_add_u32 s20, s20, 90240
    s_addc_u32 s21, s21, 0
    s_waitcnt lgkmcnt(6)
    v_mfma_f32_32x32x16_bf16 v[216:231], v[156:159], v[108:111], v[216:231]
    ds_read_b64_tr_b16 v[140:141], v15 offset:38912
    ds_read_b64_tr_b16 v[142:143], v15 offset:39168
    v_add_u32 v20, v22, v20
    s_waitcnt lgkmcnt(6)
    v_mfma_f32_32x32x16_bf16 v[216:231], v[160:163], v[112:115], v[216:231]
    ds_read_b64_tr_b16 v[144:145], v15 offset:43008
    ds_read_b64_tr_b16 v[146:147], v15 offset:43264
    buffer_load_dwordx4 v[184:187], v19, s[20:23], 0 offen sc1
    s_waitcnt lgkmcnt(6)
    v_mfma_f32_32x32x16_bf16 v[216:231], v[164:167], v[116:119], v[216:231]
    ds_read_b64_tr_b16 v[148:149], v15 offset:47104
    ds_read_b64_tr_b16 v[150:151], v15 offset:47360
    buffer_load_dwordx4 v[188:191], v19, s[20:23], 0 offen offset:1024 sc1
    s_waitcnt lgkmcnt(6)
    v_mfma_f32_32x32x16_bf16 v[216:231], v[136:139], v[120:123], v[216:231]
    buffer_load_dwordx4 v[192:195], v20, s[12:15], 0 offen sc1
    s_waitcnt lgkmcnt(4)
    v_mfma_f32_32x32x16_bf16 v[216:231], v[140:143], v[124:127], v[216:231]
    buffer_load_dwordx4 v[196:199], v20, s[24:27], 0 offen sc1
    s_waitcnt lgkmcnt(2)
    v_mfma_f32_32x32x16_bf16 v[216:231], v[144:147], v[128:131], v[216:231]
    s_add_u32 s20, s20, s45
    s_addc_u32 s21, s21, 0
    s_waitcnt lgkmcnt(0)
    v_mfma_f32_32x32x16_bf16 v[216:231], v[148:151], v[132:135], v[216:231]
    v_mad_i32_i24 v20, v22, s43, v20
L_qepi:
    s_nop 10
    v_mul_f32 v216, v201, v216
    v_mul_f32 v217, v201, v217
    v_mul_f32 v218, v201, v218
    v_mul_f32 v219, v201, v219
    v_mul_f32 v220, v200, v220
    v_mul_f32 v221, v200, v221
    v_mul_f32 v222, v200, v222
    v_mul_f32 v223, v200, v223
    v_cvt_pk_bf16_f32 v112, v216, v217
    v_cvt_pk_bf16_f32 v113, v218, v219
    v_cvt_pk_bf16_f32 v114, v220, v221
    v_cvt_pk_bf16_f32 v115, v222, v223
    ds_write_b128 v255, v[112:115] offset:49152
    v_mul_f32 v224, v200, v224
    v_mul_f32 v225, v200, v225
    v_mul_f32 v226, v200, v226
    v_mul_f32 v227, v200, v227
    v_mul_f32 v228, v202, v228
    v_mul_f32 v229, v202, v229
    v_mul_f32 v230, v202, v230
    v_mul_f32 v231, v202, v231
    v_cvt_pk_bf16_f32 v116, v224, v225
    v_cvt_pk_bf16_f32 v117, v226, v227
    v_cvt_pk_bf16_f32 v118, v228, v229
    v_cvt_pk_bf16_f32 v119, v230, v231
    ds_write_b128 v255, v[116:119] offset:50176
    s_waitcnt vmcnt(6)
    s_setprio 1
    v_mfma_f32_32x32x16_bf16 v[120:135], v[168:171], v[112:115], 0
    v_mfma_f32_32x32x16_bf16 v[120:135], v[172:175], v[116:119], v[120:135]
    s_waitcnt lgkmcnt(0)
    s_barrier
    ds_read_b128 v[88:91], v252 offset:49152
    ds_read_b128 v[92:95], v252 offset:50176
    ds_read_b128 v[96:99], v253 offset:49152
    ds_read_b128 v[100:103], v253 offset:50176
    ds_read_b128 v[104:107], v254 offset:49152
    ds_read_b128 v[108:111], v254 offset:50176
    s_waitcnt vmcnt(2)
    v_mfma_f32_32x32x16_bf16 v[136:151], v[184:187], v[112:115], 0
    s_nop 1
    v_exp_f32 v120, v120
    v_exp_f32 v121, v121
    v_exp_f32 v122, v122
    v_exp_f32 v123, v123
    v_mfma_f32_32x32x16_bf16 v[136:151], v[188:191], v[116:119], v[136:151]
    buffer_load_dword v7, v249, s[12:15], s19 offen sc1
    v_exp_f32 v124, v124
    v_exp_f32 v125, v125
    v_exp_f32 v126, v126
    v_exp_f32 v127, v127
    v_exp_f32 v128, v128
    v_exp_f32 v129, v129
    v_exp_f32 v130, v130
    v_exp_f32 v131, v131
    s_waitcnt vmcnt(5)
    s_waitcnt lgkmcnt(0)
    v_exp_f32 v132, v132
    v_exp_f32 v133, v133
    v_exp_f32 v134, v134
    v_exp_f32 v135, v135
    v_mfma_f32_32x32x16_bf16 v[152:167], v[168:171], v[88:91], 0
    v_exp_f32 v136, v136
    v_exp_f32 v137, v137
    v_exp_f32 v138, v138
    v_exp_f32 v139, v139
    v_mfma_f32_32x32x16_bf16 v[152:167], v[172:175], v[92:95], v[152:167]
    v_exp_f32 v140, v140
    v_exp_f32 v141, v141
    v_exp_f32 v142, v142
    v_exp_f32 v143, v143
    v_smfmac_f32_32x32x32_bf16 v[72:87], v[176:179], v[120:127], v5
    v_exp_f32 v144, v144
    v_exp_f32 v145, v145
    v_exp_f32 v146, v146
    v_exp_f32 v147, v147
    v_smfmac_f32_32x32x32_bf16 v[72:87], v[180:183], v[128:135], v5
    s_waitcnt vmcnt(1)
    v_exp_f32 v148, v148
    v_exp_f32 v149, v149
    v_exp_f32 v150, v150
    v_exp_f32 v151, v151
    v_mfma_f32_32x32x16_bf16 v[120:135], v[168:171], v[96:99], 0
    v_exp_f32 v152, v152
    v_exp_f32 v153, v153
    v_exp_f32 v154, v154
    v_exp_f32 v155, v155
    v_mfma_f32_32x32x16_bf16 v[120:135], v[172:175], v[100:103], v[120:135]
    v_exp_f32 v156, v156
    v_exp_f32 v157, v157
    v_exp_f32 v158, v158
    v_exp_f32 v159, v159
    v_smfmac_f32_32x32x32_bf16 v[72:87], v[192:195], v[136:143], v5
    v_exp_f32 v160, v160
    v_exp_f32 v161, v161
    v_exp_f32 v162, v162
    v_exp_f32 v163, v163
    v_smfmac_f32_32x32x32_bf16 v[72:87], v[196:199], v[144:151], v5
    v_exp_f32 v164, v164
    v_exp_f32 v165, v165
    v_exp_f32 v166, v166
    v_exp_f32 v167, v167
    v_mfma_f32_32x32x16_bf16 v[136:151], v[168:171], v[104:107], 0
    v_exp_f32 v120, v120
    v_exp_f32 v121, v121
    v_exp_f32 v122, v122
    v_exp_f32 v123, v123
    v_mfma_f32_32x32x16_bf16 v[136:151], v[172:175], v[108:111], v[136:151]
    v_exp_f32 v124, v124
    v_exp_f32 v125, v125
    v_exp_f32 v126, v126
    v_exp_f32 v127, v127
    v_smfmac_f32_32x32x32_bf16 v[24:39], v[176:179], v[152:159], v5
    v_exp_f32 v128, v128
    v_exp_f32 v129, v129
    v_exp_f32 v130, v130
    v_exp_f32 v131, v131
    v_smfmac_f32_32x32x32_bf16 v[24:39], v[180:183], v[160:167], v5
    s_waitcnt vmcnt(0)
    v_cmp_ne_u32 vcc, s41, v7
    v_exp_f32 v132, v132
    v_exp_f32 v133, v133
    v_exp_f32 v134, v134
    v_exp_f32 v135, v135
    v_mfma_f32_32x32x16_bf16 v[152:167], v[184:187], v[88:91], 0
    s_cbranch_vccnz L_lazy
L_lazyback:
    v_exp_f32 v136, v136
    v_exp_f32 v137, v137
    v_exp_f32 v138, v138
    v_exp_f32 v139, v139
    v_mfma_f32_32x32x16_bf16 v[152:167], v[188:191], v[92:95], v[152:167]
    buffer_load_dwordx4 v[200:203], v19, s[20:23], 0 offen sc1
    v_exp_f32 v140, v140
    v_exp_f32 v141, v141
    v_exp_f32 v142, v142
    v_exp_f32 v143, v143
    v_smfmac_f32_32x32x32_bf16 v[40:55], v[176:179], v[120:127], v5
    buffer_load_dwordx4 v[204:207], v19, s[20:23], 0 offen offset:1024 sc1
    v_exp_f32 v144, v144
    v_exp_f32 v145, v145
    v_exp_f32 v146, v146
    v_exp_f32 v147, v147
    v_smfmac_f32_32x32x32_bf16 v[40:55], v[180:183], v[128:135], v5
    v_exp_f32 v148, v148
    v_exp_f32 v149, v149
    v_exp_f32 v150, v150
    v_exp_f32 v151, v151
    v_mfma_f32_32x32x16_bf16 v[120:135], v[184:187], v[96:99], 0
    buffer_load_dwordx4 v[208:211], v20, s[12:15], 0 offen sc1
    v_exp_f32 v152, v152
    v_exp_f32 v153, v153
    v_exp_f32 v154, v154
    v_exp_f32 v155, v155
    v_mfma_f32_32x32x16_bf16 v[120:135], v[188:191], v[100:103], v[120:135]
    buffer_load_dwordx4 v[212:215], v20, s[24:27], 0 offen sc1
    v_exp_f32 v156, v156
    v_exp_f32 v157, v157
    v_exp_f32 v158, v158
    v_exp_f32 v159, v159
    v_smfmac_f32_32x32x32_bf16 v[56:71], v[176:179], v[136:143], v5
    s_add_u32 s20, s20, 360960
    s_addc_u32 s21, s21, 0
    v_mad_i32_i24 v20, v22, 4, v20
    v_exp_f32 v160, v160
    v_exp_f32 v161, v161
    v_exp_f32 v162, v162
    v_exp_f32 v163, v163
    v_smfmac_f32_32x32x32_bf16 v[56:71], v[180:183], v[144:151], v5
    v_exp_f32 v164, v164
    v_exp_f32 v165, v165
    v_exp_f32 v166, v166
    v_exp_f32 v167, v167
    v_mfma_f32_32x32x16_bf16 v[136:151], v[184:187], v[104:107], 0
    v_exp_f32 v120, v120
    v_exp_f32 v121, v121
    v_exp_f32 v122, v122
    v_exp_f32 v123, v123
    v_mfma_f32_32x32x16_bf16 v[136:151], v[188:191], v[108:111], v[136:151]
    buffer_load_dwordx4 v[216:219], v19, s[20:23], 0 offen sc1
    v_exp_f32 v124, v124
    v_exp_f32 v125, v125
    v_exp_f32 v126, v126
    v_exp_f32 v127, v127
    v_smfmac_f32_32x32x32_bf16 v[24:39], v[192:195], v[152:159], v5
    buffer_load_dwordx4 v[220:223], v19, s[20:23], 0 offen offset:1024 sc1
    v_exp_f32 v128, v128
    v_exp_f32 v129, v129
    v_exp_f32 v130, v130
    v_exp_f32 v131, v131
    v_smfmac_f32_32x32x32_bf16 v[24:39], v[196:199], v[160:167], v5
    s_waitcnt vmcnt(4)
    v_exp_f32 v132, v132
    v_exp_f32 v133, v133
    v_exp_f32 v134, v134
    v_exp_f32 v135, v135
    v_mfma_f32_32x32x16_bf16 v[152:167], v[200:203], v[88:91], 0
    buffer_load_dwordx4 v[224:227], v20, s[12:15], 0 offen sc1
    v_exp_f32 v136, v136
    v_exp_f32 v137, v137
    v_exp_f32 v138, v138
    v_exp_f32 v139, v139
    v_mfma_f32_32x32x16_bf16 v[152:167], v[204:207], v[92:95], v[152:167]
    buffer_load_dwordx4 v[228:231], v20, s[24:27], 0 offen sc1
    v_exp_f32 v140, v140
    v_exp_f32 v141, v141
    v_exp_f32 v142, v142
    v_exp_f32 v143, v143
    v_smfmac_f32_32x32x32_bf16 v[40:55], v[192:195], v[120:127], v5
    s_add_u32 s20, s20, 360960
    s_addc_u32 s21, s21, 0
    v_mad_i32_i24 v20, v22, 4, v20
    v_exp_f32 v144, v144
    v_exp_f32 v145, v145
    v_exp_f32 v146, v146
    v_exp_f32 v147, v147
    v_smfmac_f32_32x32x32_bf16 v[40:55], v[196:199], v[128:135], v5
    v_exp_f32 v148, v148
    v_exp_f32 v149, v149
    v_exp_f32 v150, v150
    v_exp_f32 v151, v151
    v_mfma_f32_32x32x16_bf16 v[120:135], v[200:203], v[96:99], 0
    v_exp_f32 v152, v152
    v_exp_f32 v153, v153
    v_exp_f32 v154, v154
    v_exp_f32 v155, v155
    v_mfma_f32_32x32x16_bf16 v[120:135], v[204:207], v[100:103], v[120:135]
    buffer_load_dwordx4 v[232:235], v19, s[20:23], 0 offen sc1
    v_exp_f32 v156, v156
    v_exp_f32 v157, v157
    v_exp_f32 v158, v158
    v_exp_f32 v159, v159
    v_smfmac_f32_32x32x32_bf16 v[56:71], v[192:195], v[136:143], v5
    buffer_load_dwordx4 v[236:239], v19, s[20:23], 0 offen offset:1024 sc1
    v_exp_f32 v160, v160
    v_exp_f32 v161, v161
    v_exp_f32 v162, v162
    v_exp_f32 v163, v163
    v_smfmac_f32_32x32x32_bf16 v[56:71], v[196:199], v[144:151], v5
    s_waitcnt vmcnt(6)
    v_exp_f32 v164, v164
    v_exp_f32 v165, v165
    v_exp_f32 v166, v166
    v_exp_f32 v167, v167
    v_mfma_f32_32x32x16_bf16 v[136:151], v[200:203], v[104:107], 0
    buffer_load_dwordx4 v[240:243], v20, s[12:15], 0 offen sc1
    v_exp_f32 v120, v120
    v_exp_f32 v121, v121
    v_exp_f32 v122, v122
    v_exp_f32 v123, v123
    v_mfma_f32_32x32x16_bf16 v[136:151], v[204:207], v[108:111], v[136:151]
    buffer_load_dwordx4 v[244:247], v20, s[24:27], 0 offen sc1
    v_exp_f32 v124, v124
    v_exp_f32 v125, v125
    v_exp_f32 v126, v126
    v_exp_f32 v127, v127
    v_smfmac_f32_32x32x32_bf16 v[24:39], v[208:211], v[152:159], v5
    s_add_u32 s20, s20, 360960
    s_addc_u32 s21, s21, 0
    v_mad_i32_i24 v20, v22, 4, v20
    v_exp_f32 v128, v128
    v_exp_f32 v129, v129
    v_exp_f32 v130, v130
    v_exp_f32 v131, v131
    v_smfmac_f32_32x32x32_bf16 v[24:39], v[212:215], v[160:167], v5
    v_exp_f32 v132, v132
    v_exp_f32 v133, v133
    v_exp_f32 v134, v134
    v_exp_f32 v135, v135
    v_mfma_f32_32x32x16_bf16 v[152:167], v[200:203], v[112:115], 0
    v_exp_f32 v136, v136
    v_exp_f32 v137, v137
    v_exp_f32 v138, v138
    v_exp_f32 v139, v139
    v_mfma_f32_32x32x16_bf16 v[152:167], v[204:207], v[116:119], v[152:167]
    v_exp_f32 v140, v140
    v_exp_f32 v141, v141
    v_exp_f32 v142, v142
    v_exp_f32 v143, v143
    v_smfmac_f32_32x32x32_bf16 v[40:55], v[208:211], v[120:127], v5
    v_exp_f32 v144, v144
    v_exp_f32 v145, v145
    v_exp_f32 v146, v146
    v_exp_f32 v147, v147
    v_smfmac_f32_32x32x32_bf16 v[40:55], v[212:215], v[128:135], v5
    buffer_load_dword v7, v248, s[12:15], 0 offen sc1
    s_waitcnt vmcnt(7)
    v_exp_f32 v148, v148
    v_exp_f32 v149, v149
    v_exp_f32 v150, v150
    v_exp_f32 v151, v151
    v_mfma_f32_32x32x16_bf16 v[120:135], v[216:219], v[88:91], 0
    s_cmp_eq_u32 s67, 12
    v_exp_f32 v152, v152
    v_exp_f32 v153, v153
    v_exp_f32 v154, v154
    v_exp_f32 v155, v155
    v_mfma_f32_32x32x16_bf16 v[120:135], v[220:223], v[92:95], v[120:135]
    buffer_load_dwordx4 v[168:171], v19, s[20:23], 0 offen sc1
    v_exp_f32 v156, v156
    v_exp_f32 v157, v157
    v_exp_f32 v158, v158
    v_exp_f32 v159, v159
    v_smfmac_f32_32x32x32_bf16 v[56:71], v[208:211], v[136:143], v5
    s_cselect_b32 s43, -52, 4
    s_cselect_b32 s49, -1, 0
    v_exp_f32 v160, v160
    v_exp_f32 v161, v161
    v_exp_f32 v162, v162
    v_exp_f32 v163, v163
    v_smfmac_f32_32x32x32_bf16 v[56:71], v[212:215], v[144:151], v5
    v_exp_f32 v164, v164
    v_exp_f32 v165, v165
    v_exp_f32 v166, v166
    v_exp_f32 v167, v167
    v_mfma_f32_32x32x16_bf16 v[136:151], v[216:219], v[96:99], 0
    s_mul_i32 s45, s43, 90240
    v_exp_f32 v120, v120
    v_exp_f32 v121, v121
    v_exp_f32 v122, v122
    v_exp_f32 v123, v123
    v_mfma_f32_32x32x16_bf16 v[136:151], v[220:223], v[100:103], v[136:151]
    buffer_load_dwordx4 v[172:175], v19, s[20:23], 0 offen offset:1024 sc1
    v_exp_f32 v124, v124
    v_exp_f32 v125, v125
    v_exp_f32 v126, v126
    v_exp_f32 v127, v127
    v_smfmac_f32_32x32x32_bf16 v[72:87], v[208:211], v[152:159], v5
    s_add_u32 s20, s20, s45
    s_addc_u32 s21, s21, s49
    v_exp_f32 v128, v128
    v_exp_f32 v129, v129
    v_exp_f32 v130, v130
    v_exp_f32 v131, v131
    v_smfmac_f32_32x32x32_bf16 v[72:87], v[212:215], v[160:167], v5
    s_waitcnt vmcnt(7)
    v_exp_f32 v132, v132
    v_exp_f32 v133, v133
    v_exp_f32 v134, v134
    v_exp_f32 v135, v135
    v_mfma_f32_32x32x16_bf16 v[152:167], v[216:219], v[104:107], 0
    buffer_load_dwordx4 v[176:179], v20, s[12:15], 0 offen sc1
    v_exp_f32 v136, v136
    v_exp_f32 v137, v137
    v_exp_f32 v138, v138
    v_exp_f32 v139, v139
    v_mfma_f32_32x32x16_bf16 v[152:167], v[220:223], v[108:111], v[152:167]
    v_exp_f32 v140, v140
    v_exp_f32 v141, v141
    v_exp_f32 v142, v142
    v_exp_f32 v143, v143
    v_smfmac_f32_32x32x32_bf16 v[24:39], v[224:227], v[120:127], v5
    v_exp_f32 v144, v144
    v_exp_f32 v145, v145
    v_exp_f32 v146, v146
    v_exp_f32 v147, v147
    v_smfmac_f32_32x32x32_bf16 v[24:39], v[228:231], v[128:135], v5
    v_exp_f32 v148, v148
    v_exp_f32 v149, v149
    v_exp_f32 v150, v150
    v_exp_f32 v151, v151
    v_mfma_f32_32x32x16_bf16 v[120:135], v[216:219], v[112:115], 0
    buffer_load_dwordx4 v[180:183], v20, s[24:27], 0 offen sc1
    v_exp_f32 v152, v152
    v_exp_f32 v153, v153
    v_exp_f32 v154, v154
    v_exp_f32 v155, v155
    v_mfma_f32_32x32x16_bf16 v[120:135], v[220:223], v[116:119], v[120:135]
    v_exp_f32 v156, v156
    v_exp_f32 v157, v157
    v_exp_f32 v158, v158
    v_exp_f32 v159, v159
    v_smfmac_f32_32x32x32_bf16 v[40:55], v[224:227], v[136:143], v5
    v_mad_i32_i24 v20, v22, s43, v20
    v_exp_f32 v160, v160
    v_exp_f32 v161, v161
    v_exp_f32 v162, v162
    v_exp_f32 v163, v163
    v_smfmac_f32_32x32x32_bf16 v[40:55], v[228:231], v[144:151], v5
    s_waitcnt vmcnt(4)
    v_cmp_ne_u32 vcc, s41, v7
    s_waitcnt vmcnt(7)
    v_exp_f32 v164, v164
    v_exp_f32 v165, v165
    v_exp_f32 v166, v166
    v_exp_f32 v167, v167
    v_mfma_f32_32x32x16_bf16 v[136:151], v[232:235], v[88:91], 0
    s_cbranch_vccnz L_lazy3
L_lazyback3:
    v_exp_f32 v120, v120
    v_exp_f32 v121, v121
    v_exp_f32 v122, v122
    v_exp_f32 v123, v123
    v_mfma_f32_32x32x16_bf16 v[136:151], v[236:239], v[92:95], v[136:151]
    buffer_load_dwordx4 v[184:187], v19, s[20:23], 0 offen sc1
    v_exp_f32 v124, v124
    v_exp_f32 v125, v125
    v_exp_f32 v126, v126
    v_exp_f32 v127, v127
    v_smfmac_f32_32x32x32_bf16 v[56:71], v[224:227], v[152:159], v5
    v_exp_f32 v128, v128
    v_exp_f32 v129, v129
    v_exp_f32 v130, v130
    v_exp_f32 v131, v131
    v_smfmac_f32_32x32x32_bf16 v[56:71], v[228:231], v[160:167], v5
    v_exp_f32 v132, v132
    v_exp_f32 v133, v133
    v_exp_f32 v134, v134
    v_exp_f32 v135, v135
    s_branch L_pg_B3
.p2align 12
L_stub_B3:
    s_branch L_backB
    s_nop 0
L_pg_B3:
    v_mfma_f32_32x32x16_bf16 v[152:167], v[232:235], v[96:99], 0
    v_exp_f32 v136, v136
    v_exp_f32 v137, v137
    v_exp_f32 v138, v138
    v_exp_f32 v139, v139
    v_mfma_f32_32x32x16_bf16 v[152:167], v[236:239], v[100:103], v[152:167]
    buffer_load_dwordx4 v[188:191], v19, s[20:23], 0 offen offset:1024 sc1
    v_exp_f32 v140, v140
    v_exp_f32 v141, v141
    v_exp_f32 v142, v142
    v_exp_f32 v143, v143
    v_smfmac_f32_32x32x32_bf16 v[72:87], v[224:227], v[120:127], v5
    s_add_u32 s20, s20, 360960
    s_addc_u32 s21, s21, 0
    v_exp_f32 v144, v144
    v_exp_f32 v145, v145
    v_exp_f32 v146, v146
    v_exp_f32 v147, v147
    v_smfmac_f32_32x32x32_bf16 v[72:87], v[228:231], v[128:135], v5
    s_waitcnt vmcnt(7)
    v_exp_f32 v148, v148
    v_exp_f32 v149, v149
    v_exp_f32 v150, v150
    v_exp_f32 v151, v151
    v_mfma_f32_32x32x16_bf16 v[120:135], v[232:235], v[104:107], 0
    buffer_load_dwordx4 v[192:195], v20, s[12:15], 0 offen sc1
    v_exp_f32 v152, v152
    v_exp_f32 v153, v153
    v_exp_f32 v154, v154
    v_exp_f32 v155, v155
    v_mfma_f32_32x32x16_bf16 v[120:135], v[236:239], v[108:111], v[120:135]
    v_exp_f32 v156, v156
    v_exp_f32 v157, v157
    v_exp_f32 v158, v158
    v_exp_f32 v159, v159
    v_smfmac_f32_32x32x32_bf16 v[24:39], v[240:243], v[136:143], v5
    v_exp_f32 v160, v160
    v_exp_f32 v161, v161
    v_exp_f32 v162, v162
    v_exp_f32 v163, v163
    v_smfmac_f32_32x32x32_bf16 v[24:39], v[244:247], v[144:151], v5
    v_exp_f32 v164, v164
    v_exp_f32 v165, v165
    v_exp_f32 v166, v166
    v_exp_f32 v167, v167
    v_mfma_f32_32x32x16_bf16 v[136:151], v[232:235], v[112:115], 0
    buffer_load_dwordx4 v[196:199], v20, s[24:27], 0 offen sc1
    v_exp_f32 v120, v120
    v_exp_f32 v121, v121
    v_exp_f32 v122, v122
    v_exp_f32 v123, v123
    v_mfma_f32_32x32x16_bf16 v[136:151], v[236:239], v[116:119], v[136:151]
    s_barrier
    v_exp_f32 v124, v124
    v_exp_f32 v125, v125
    v_exp_f32 v126, v126
    v_exp_f32 v127, v127
    v_smfmac_f32_32x32x32_bf16 v[40:55], v[240:243], v[152:159], v5
    v_mad_i32_i24 v20, v22, 4, v20
    s_add_u32 m0, s63, 23552
    v_exp_f32 v128, v128
    v_exp_f32 v129, v129
    v_exp_f32 v130, v130
    v_exp_f32 v131, v131
    v_smfmac_f32_32x32x32_bf16 v[40:55], v[244:247], v[160:167], v5
    s_waitcnt vmcnt(6)
    v_exp_f32 v132, v132
    v_exp_f32 v133, v133
    v_exp_f32 v134, v134
    v_exp_f32 v135, v135
    v_mfma_f32_32x32x16_bf16 v[152:167], v[168:171], v[88:91], 0
    buffer_load_dwordx4 v21, s[32:35], 0 offen lds
    v_exp_f32 v136, v136
    v_exp_f32 v137, v137
    v_exp_f32 v138, v138
    v_exp_f32 v139, v139
    v_mfma_f32_32x32x16_bf16 v[152:167], v[172:175], v[92:95], v[152:167]
    buffer_load_dwordx4 v[200:203], v19, s[20:23], 0 offen sc1
    v_exp_f32 v140, v140
    v_exp_f32 v141, v141
    v_exp_f32 v142, v142
    v_exp_f32 v143, v143
    v_smfmac_f32_32x32x32_bf16 v[56:71], v[240:243], v[120:127], v5
    s_add_u32 s32, s32, 28672
    s_addc_u32 s33, s33, 0
    v_exp_f32 v144, v144
    v_exp_f32 v145, v145
    v_exp_f32 v146, v146
    v_exp_f32 v147, v147
    v_smfmac_f32_32x32x32_bf16 v[56:71], v[244:247], v[128:135], v5
    v_exp_f32 v148, v148
    v_exp_f32 v149, v149
    v_exp_f32 v150, v150
    v_exp_f32 v151, v151
    v_mfma_f32_32x32x16_bf16 v[120:135], v[168:171], v[96:99], 0
    s_add_u32 m0, s63, 27648
    v_exp_f32 v152, v152
    v_exp_f32 v153, v153
    v_exp_f32 v154, v154
    v_exp_f32 v155, v155
    v_mfma_f32_32x32x16_bf16 v[120:135], v[172:175], v[100:103], v[120:135]
    buffer_load_dwordx4 v[204:207], v19, s[20:23], 0 offen offset:1024 sc1
    v_exp_f32 v156, v156
    v_exp_f32 v157, v157
    v_exp_f32 v158, v158
    v_exp_f32 v159, v159
    v_smfmac_f32_32x32x32_bf16 v[72:87], v[240:243], v[136:143], v5
    s_add_u32 s20, s20, 360960
    s_addc_u32 s21, s21, 0
    v_exp_f32 v160, v160
    v_exp_f32 v161, v161
    v_exp_f32 v162, v162
    v_exp_f32 v163, v163
    v_smfmac_f32_32x32x32_bf16 v[72:87], v[244:247], v[144:151], v5
    s_waitcnt vmcnt(7)
    v_exp_f32 v164, v164
    v_exp_f32 v165, v165
    v_exp_f32 v166, v166
    v_exp_f32 v167, v167
    v_mfma_f32_32x32x16_bf16 v[136:151], v[168:171], v[104:107], 0
    buffer_load_dwordx4 v[208:211], v20, s[12:15], 0 offen sc1
    v_exp_f32 v120, v120
    v_exp_f32 v121, v121
    v_exp_f32 v122, v122
    v_exp_f32 v123, v123
    v_mfma_f32_32x32x16_bf16 v[136:151], v[172:175], v[108:111], v[136:151]
    buffer_load_dwordx4 v21, s[32:35], 0 offen lds
    v_exp_f32 v124, v124
    v_exp_f32 v125, v125
    v_exp_f32 v126, v126
    v_exp_f32 v127, v127
    v_smfmac_f32_32x32x32_bf16 v[24:39], v[176:179], v[152:159], v5
    s_add_u32 s32, s32, 28672
    s_addc_u32 s33, s33, 0
    v_exp_f32 v128, v128
    v_exp_f32 v129, v129
    v_exp_f32 v130, v130
    v_exp_f32 v131, v131
    v_smfmac_f32_32x32x32_bf16 v[24:39], v[180:183], v[160:167], v5
    v_exp_f32 v132, v132
    v_exp_f32 v133, v133
    v_exp_f32 v134, v134
    v_exp_f32 v135, v135
    v_mfma_f32_32x32x16_bf16 v[152:167], v[168:171], v[112:115], 0
    buffer_load_dwordx4 v[212:215], v20, s[24:27], 0 offen sc1
    v_exp_f32 v136, v136
    v_exp_f32 v137, v137
    v_exp_f32 v138, v138
    v_exp_f32 v139, v139
    v_mfma_f32_32x32x16_bf16 v[152:167], v[172:175], v[116:119], v[152:167]
    s_add_u32 m0, s63, 31744
    v_exp_f32 v140, v140
    v_exp_f32 v141, v141
    v_exp_f32 v142, v142
    v_exp_f32 v143, v143
    v_smfmac_f32_32x32x32_bf16 v[40:55], v[176:179], v[120:127], v5
    v_mad_i32_i24 v20, v22, 4, v20
    v_exp_f32 v144, v144
    v_exp_f32 v145, v145
    v_exp_f32 v146, v146
    v_exp_f32 v147, v147
    v_smfmac_f32_32x32x32_bf16 v[40:55], v[180:183], v[128:135], v5
    s_waitcnt vmcnt(8)
    v_exp_f32 v148, v148
    v_exp_f32 v149, v149
    v_exp_f32 v150, v150
    v_exp_f32 v151, v151
    v_mfma_f32_32x32x16_bf16 v[120:135], v[184:187], v[88:91], 0
    buffer_load_dwordx4 v21, s[32:35], 0 offen lds
    v_exp_f32 v152, v152
    v_exp_f32 v153, v153
    v_exp_f32 v154, v154
    v_exp_f32 v155, v155
    v_mfma_f32_32x32x16_bf16 v[120:135], v[188:191], v[92:95], v[120:135]
    buffer_load_dwordx4 v[216:219], v19, s[20:23], 0 offen sc1
    v_exp_f32 v156, v156
    v_exp_f32 v157, v157
    v_exp_f32 v158, v158
    v_exp_f32 v159, v159
    v_smfmac_f32_32x32x32_bf16 v[56:71], v[176:179], v[136:143], v5
    s_add_u32 s32, s32, 28672
    s_addc_u32 s33, s33, 0
    v_exp_f32 v160, v160
    v_exp_f32 v161, v161
    v_exp_f32 v162, v162
    v_exp_f32 v163, v163
    v_smfmac_f32_32x32x32_bf16 v[56:71], v[180:183], v[144:151], v5
    v_exp_f32 v164, v164
    v_exp_f32 v165, v165
    v_exp_f32 v166, v166
    v_exp_f32 v167, v167
    v_mfma_f32_32x32x16_bf16 v[136:151], v[184:187], v[96:99], 0
    s_add_u32 m0, s63, 35840
    v_exp_f32 v120, v120
    v_exp_f32 v121, v121
    v_exp_f32 v122, v122
    v_exp_f32 v123, v123
    v_mfma_f32_32x32x16_bf16 v[136:151], v[188:191], v[100:103], v[136:151]
    buffer_load_dwordx4 v[220:223], v19, s[20:23], 0 offen offset:1024 sc1
    v_exp_f32 v124, v124
    v_exp_f32 v125, v125
    v_exp_f32 v126, v126
    v_exp_f32 v127, v127
    v_smfmac_f32_32x32x32_bf16 v[72:87], v[176:179], v[152:159], v5
    s_add_u32 s20, s20, 360960
    s_addc_u32 s21, s21, 0
    v_exp_f32 v128, v128
    v_exp_f32 v129, v129
    v_exp_f32 v130, v130
    v_exp_f32 v131, v131
    v_smfmac_f32_32x32x32_bf16 v[72:87], v[180:183], v[160:167], v5
    s_waitcnt vmcnt(9)
    v_exp_f32 v132, v132
    v_exp_f32 v133, v133
    v_exp_f32 v134, v134
    v_exp_f32 v135, v135
    v_mfma_f32_32x32x16_bf16 v[152:167], v[184:187], v[104:107], 0
    buffer_load_dwordx4 v[224:227], v20, s[12:15], 0 offen sc1
    v_exp_f32 v136, v136
    v_exp_f32 v137, v137
    v_exp_f32 v138, v138
    v_exp_f32 v139, v139
    v_mfma_f32_32x32x16_bf16 v[152:167], v[188:191], v[108:111], v[152:167]
    buffer_load_dwordx4 v21, s[32:35], 0 offen lds
    v_exp_f32 v140, v140
    v_exp_f32 v141, v141
    v_exp_f32 v142, v142
    v_exp_f32 v143, v143
    v_smfmac_f32_32x32x32_bf16 v[24:39], v[192:195], v[120:127], v5
    s_add_u32 s32, s32, 28672
    s_addc_u32 s33, s33, 0
    v_exp_f32 v144, v144
    v_exp_f32 v145, v145
    v_exp_f32 v146, v146
    v_exp_f32 v147, v147
    v_smfmac_f32_32x32x32_bf16 v[24:39], v[196:199], v[128:135], v5
    v_exp_f32 v148, v148
    v_exp_f32 v149, v149
    v_exp_f32 v150, v150
    v_exp_f32 v151, v151
    v_mfma_f32_32x32x16_bf16 v[120:135], v[184:187], v[112:115], 0
    buffer_load_dwordx4 v[228:231], v20, s[24:27], 0 offen sc1
    v_exp_f32 v152, v152
    v_exp_f32 v153, v153
    v_exp_f32 v154, v154
    v_exp_f32 v155, v155
    v_mfma_f32_32x32x16_bf16 v[120:135], v[188:191], v[116:119], v[120:135]
    s_add_u32 m0, s63, 39936
    v_exp_f32 v156, v156
    v_exp_f32 v157, v157
    v_exp_f32 v158, v158
    v_exp_f32 v159, v159
    v_smfmac_f32_32x32x32_bf16 v[40:55], v[192:195], v[136:143], v5
    v_mad_i32_i24 v20, v22, 4, v20
    v_exp_f32 v160, v160
    v_exp_f32 v161, v161
    v_exp_f32 v162, v162
    v_exp_f32 v163, v163
    v_smfmac_f32_32x32x32_bf16 v[40:55], v[196:199], v[144:151], v5
    s_waitcnt vmcnt(9)
    v_exp_f32 v164, v164
    v_exp_f32 v165, v165
    v_exp_f32 v166, v166
    v_exp_f32 v167, v167
    v_mfma_f32_32x32x16_bf16 v[136:151], v[200:203], v[88:91], 0
    s_cmp_eq_u32 s67, 8
    v_exp_f32 v120, v120
    v_exp_f32 v121, v121
    v_exp_f32 v122, v122
    v_exp_f32 v123, v123
    v_mfma_f32_32x32x16_bf16 v[136:151], v[204:207], v[92:95], v[136:151]
    buffer_load_dwordx4 v[232:235], v19, s[20:23], 0 offen sc1
    v_exp_f32 v124, v124
    v_exp_f32 v125, v125
    v_exp_f32 v126, v126
    v_exp_f32 v127, v127
    v_smfmac_f32_32x32x32_bf16 v[56:71], v[192:195], v[152:159], v5
    s_cselect_b32 s43, -52, 4
    s_cselect_b32 s49, -1, 0
    v_exp_f32 v128, v128
    v_exp_f32 v129, v129
    v_exp_f32 v130, v130
    v_exp_f32 v131, v131
    v_smfmac_f32_32x32x32_bf16 v[56:71], v[196:199], v[160:167], v5
    buffer_load_dwordx4 v21, s[32:35], 0 offen lds
    v_exp_f32 v132, v132
    v_exp_f32 v133, v133
    v_exp_f32 v134, v134
    v_exp_f32 v135, v135
    v_mfma_f32_32x32x16_bf16 v[152:167], v[200:203], v[96:99], 0
    s_mul_i32 s45, s43, 90240
    v_exp_f32 v136, v136
    v_exp_f32 v137, v137
    v_exp_f32 v138, v138
    v_exp_f32 v139, v139
    v_mfma_f32_32x32x16_bf16 v[152:167], v[204:207], v[100:103], v[152:167]
    buffer_load_dwordx4 v[236:239], v19, s[20:23], 0 offen offset:1024 sc1
    v_exp_f32 v140, v140
    v_exp_f32 v141, v141
    v_exp_f32 v142, v142
    v_exp_f32 v143, v143
    v_smfmac_f32_32x32x32_bf16 v[72:87], v[192:195], v[120:127], v5
    s_add_u32 s20, s20, s45
    s_addc_u32 s21, s21, s49
    v_exp_f32 v144, v144
    v_exp_f32 v145, v145
    v_exp_f32 v146, v146
    v_exp_f32 v147, v147
    v_smfmac_f32_32x32x32_bf16 v[72:87], v[196:199], v[128:135], v5
    s_waitcnt vmcnt(9)
    v_exp_f32 v148, v148
    v_exp_f32 v149, v149
    v_exp_f32 v150, v150
    v_exp_f32 v151, v151
    v_mfma_f32_32x32x16_bf16 v[120:135], v[200:203], v[104:107], 0
    buffer_load_dwordx4 v[240:243], v20, s[12:15], 0 offen sc1
    v_exp_f32 v152, v152
    v_exp_f32 v153, v153
    v_exp_f32 v154, v154
    v_exp_f32 v155, v155
    v_mfma_f32_32x32x16_bf16 v[120:135], v[204:207], v[108:111], v[120:135]
    v_exp_f32 v156, v156
    v_exp_f32 v157, v157
    v_exp_f32 v158, v158
    v_exp_f32 v159, v159
    v_smfmac_f32_32x32x32_bf16 v[24:39], v[208:211], v[136:143], v5
    s_add_u32 s32, s32, 28672
    s_addc_u32 s33, s33, 0
    v_exp_f32 v160, v160
    v_exp_f32 v161, v161
    v_exp_f32 v162, v162
    v_exp_f32 v163, v163
    v_smfmac_f32_32x32x32_bf16 v[24:39], v[212:215], v[144:151], v5
    s_add_u32 m0, s63, 44032
    v_exp_f32 v164, v164
    v_exp_f32 v165, v165
    v_exp_f32 v166, v166
    v_exp_f32 v167, v167
    v_mfma_f32_32x32x16_bf16 v[136:151], v[200:203], v[112:115], 0
    buffer_load_dwordx4 v[244:247], v20, s[24:27], 0 offen sc1
    v_exp_f32 v120, v120
    v_exp_f32 v121, v121
    v_exp_f32 v122, v122
    v_exp_f32 v123, v123
    v_mfma_f32_32x32x16_bf16 v[136:151], v[204:207], v[116:119], v[136:151]
    buffer_load_dwordx4 v21, s[32:35], 0 offen lds
    v_exp_f32 v124, v124
    v_exp_f32 v125, v125
    v_exp_f32 v126, v126
    v_exp_f32 v127, v127
    v_smfmac_f32_32x32x32_bf16 v[40:55], v[208:211], v[152:159], v5
    v_mad_i32_i24 v20, v22, s43, v20
    v_exp_f32 v128, v128
    v_exp_f32 v129, v129
    v_exp_f32 v130, v130
    v_exp_f32 v131, v131
    v_smfmac_f32_32x32x32_bf16 v[40:55], v[212:215], v[160:167], v5
    s_waitcnt vmcnt(9)
    v_exp_f32 v132, v132
    v_exp_f32 v133, v133
    v_exp_f32 v134, v134
    v_exp_f32 v135, v135
    v_mfma_f32_32x32x16_bf16 v[152:167], v[216:219], v[88:91], 0
    v_exp_f32 v136, v136
    v_exp_f32 v137, v137
    v_exp_f32 v138, v138
    v_exp_f32 v139, v139
    v_mfma_f32_32x32x16_bf16 v[152:167], v[220:223], v[92:95], v[152:167]
    buffer_load_dwordx4 v[168:171], v19, s[20:23], 0 offen sc1
    v_exp_f32 v140, v140
    v_exp_f32 v141, v141
    v_exp_f32 v142, v142
    v_exp_f32 v143, v143
    v_smfmac_f32_32x32x32_bf16 v[56:71], v[208:211], v[120:127], v5
    s_add_u32 s32, s32, 28672
    s_addc_u32 s33, s33, 0
    v_exp_f32 v144, v144
    v_exp_f32 v145, v145
    v_exp_f32 v146, v146
    v_exp_f32 v147, v147
    v_smfmac_f32_32x32x32_bf16 v[56:71], v[212:215], v[128:135], v5
    s_add_u32 m0, s63, 48128
    v_exp_f32 v148, v148
    v_exp_f32 v149, v149
    v_exp_f32 v150, v150
    v_exp_f32 v151, v151
    v_mfma_f32_32x32x16_bf16 v[120:135], v[216:219], v[96:99], 0
    buffer_load_dwordx4 v21, s[32:35], 0 offen lds
    v_exp_f32 v152, v152
    v_exp_f32 v153, v153
    v_exp_f32 v154, v154
    v_exp_f32 v155, v155
    v_mfma_f32_32x32x16_bf16 v[120:135], v[220:223], v[100:103], v[120:135]
    buffer_load_dwordx4 v[172:175], v19, s[20:23], 0 offen offset:1024 sc1
    v_exp_f32 v156, v156
    v_exp_f32 v157, v157
    v_exp_f32 v158, v158
    v_exp_f32 v159, v159
    v_smfmac_f32_32x32x32_bf16 v[72:87], v[208:211], v[136:143], v5
    s_add_u32 s20, s20, 360960
    s_addc_u32 s21, s21, 0
    v_exp_f32 v160, v160
    v_exp_f32 v161, v161
    v_exp_f32 v162, v162
    v_exp_f32 v163, v163
    v_smfmac_f32_32x32x32_bf16 v[72:87], v[212:215], v[144:151], v5
    s_waitcnt vmcnt(9)
    v_exp_f32 v164, v164
    v_exp_f32 v165, v165
    v_exp_f32 v166, v166
    v_exp_f32 v167, v167
    v_mfma_f32_32x32x16_bf16 v[136:151], v[216:219], v[104:107], 0
    buffer_load_dwordx4 v[176:179], v20, s[12:15], 0 offen sc1
    v_exp_f32 v120, v120
    v_exp_f32 v121, v121
    v_exp_f32 v122, v122
    v_exp_f32 v123, v123
    v_mfma_f32_32x32x16_bf16 v[136:151], v[220:223], v[108:111], v[136:151]
    v_exp_f32 v124, v124
    v_exp_f32 v125, v125
    v_exp_f32 v126, v126
    v_exp_f32 v127, v127
    v_smfmac_f32_32x32x32_bf16 v[24:39], v[224:227], v[152:159], v5
    s_add_u32 s32, s32, 28672
    s_addc_u32 s33, s33, 0
    v_exp_f32 v128, v128
    v_exp_f32 v129, v129
    v_exp_f32 v130, v130
    v_exp_f32 v131, v131
    v_smfmac_f32_32x32x32_bf16 v[24:39], v[228:231], v[160:167], v5
    s_add_u32 m0, s63, 52224
    v_exp_f32 v132, v132
    v_exp_f32 v133, v133
    v_exp_f32 v134, v134
    v_exp_f32 v135, v135
    v_mfma_f32_32x32x16_bf16 v[152:167], v[216:219], v[112:115], 0
    buffer_load_dwordx4 v[180:183], v20, s[24:27], 0 offen sc1
    v_exp_f32 v136, v136
    v_exp_f32 v137, v137
    v_exp_f32 v138, v138
    v_exp_f32 v139, v139
    v_mfma_f32_32x32x16_bf16 v[152:167], v[220:223], v[116:119], v[152:167]
    buffer_load_dwordx4 v21, s[32:35], 0 offen lds
    v_exp_f32 v140, v140
    v_exp_f32 v141, v141
    v_exp_f32 v142, v142
    v_exp_f32 v143, v143
    v_smfmac_f32_32x32x32_bf16 v[40:55], v[224:227], v[120:127], v5
    v_mad_i32_i24 v20, v22, 4, v20
    v_exp_f32 v144, v144
    v_exp_f32 v145, v145
    v_exp_f32 v146, v146
    v_exp_f32 v147, v147
    v_smfmac_f32_32x32x32_bf16 v[40:55], v[228:231], v[128:135], v5
    s_waitcnt vmcnt(9)
    v_exp_f32 v148, v148
    v_exp_f32 v149, v149
    v_exp_f32 v150, v150
    v_exp_f32 v151, v151
    v_mfma_f32_32x32x16_bf16 v[120:135], v[232:235], v[88:91], 0
    v_exp_f32 v152, v152
    v_exp_f32 v153, v153
    v_exp_f32 v154, v154
    v_exp_f32 v155, v155
    v_mfma_f32_32x32x16_bf16 v[120:135], v[236:239], v[92:95], v[120:135]
    buffer_load_dwordx4 v[184:187], v19, s[20:23], 0 offen sc1
    v_exp_f32 v156, v156
    v_exp_f32 v157, v157
    v_exp_f32 v158, v158
    v_exp_f32 v159, v159
    v_smfmac_f32_32x32x32_bf16 v[56:71], v[224:227], v[136:143], v5
    s_add_u32 s32, s32, 28672
    s_addc_u32 s33, s33, 0
    v_exp_f32 v160, v160
    v_exp_f32 v161, v161
    v_exp_f32 v162, v162
    v_exp_f32 v163, v163
    v_smfmac_f32_32x32x32_bf16 v[56:71], v[228:231], v[144:151], v5
    s_add_u32 m0, s63, 56320
    v_exp_f32 v164, v164
    v_exp_f32 v165, v165
    v_exp_f32 v166, v166
    v_exp_f32 v167, v167
    v_mfma_f32_32x32x16_bf16 v[136:151], v[232:235], v[96:99], 0
    buffer_load_dwordx4 v21, s[32:35], 0 offen lds
    v_exp_f32 v120, v120
    v_exp_f32 v121, v121
    v_exp_f32 v122, v122
    v_exp_f32 v123, v123
    v_mfma_f32_32x32x16_bf16 v[136:151], v[236:239], v[100:103], v[136:151]
    buffer_load_dwordx4 v[188:191], v19, s[20:23], 0 offen offset:1024 sc1
    v_exp_f32 v124, v124
    v_exp_f32 v125, v125
    v_exp_f32 v126, v126
    v_exp_f32 v127, v127
    v_smfmac_f32_32x32x32_bf16 v[72:87], v[224:227], v[152:159], v5
    s_add_u32 s20, s20, 360960
    s_addc_u32 s21, s21, 0
    v_exp_f32 v128, v128
    v_exp_f32 v129, v129
    v_exp_f32 v130, v130
    v_exp_f32 v131, v131
    v_smfmac_f32_32x32x32_bf16 v[72:87], v[228:231], v[160:167], v5
    s_waitcnt vmcnt(10)
    v_exp_f32 v132, v132
    v_exp_f32 v133, v133
    v_exp_f32 v134, v134
    v_exp_f32 v135, v135
    v_mfma_f32_32x32x16_bf16 v[152:167], v[232:235], v[104:107], 0
    buffer_load_dwordx4 v[192:195], v20, s[12:15], 0 offen sc1
    v_exp_f32 v136, v136
    v_exp_f32 v137, v137
    v_exp_f32 v138, v138
    v_exp_f32 v139, v139
    v_mfma_f32_32x32x16_bf16 v[152:167], v[236:239], v[108:111], v[152:167]
    v_exp_f32 v140, v140
    v_exp_f32 v141, v141
    v_exp_f32 v142, v142
    v_exp_f32 v143, v143
    v_smfmac_f32_32x32x32_bf16 v[24:39], v[240:243], v[120:127], v5
    s_add_u32 s32, s32, 28672
    s_addc_u32 s33, s33, 0
    v_exp_f32 v144, v144
    v_exp_f32 v145, v145
    v_exp_f32 v146, v146
    v_exp_f32 v147, v147
    v_smfmac_f32_32x32x32_bf16 v[24:39], v[244:247], v[128:135], v5
    s_add_u32 m0, s63, 60416
    v_exp_f32 v148, v148
    v_exp_f32 v149, v149
    v_exp_f32 v150, v150
    v_exp_f32 v151, v151
    v_mfma_f32_32x32x16_bf16 v[120:135], v[232:235], v[112:115], 0
    buffer_load_dwordx4 v[196:199], v20, s[24:27], 0 offen sc1
    v_exp_f32 v152, v152
    v_exp_f32 v153, v153
    v_exp_f32 v154, v154
    v_exp_f32 v155, v155
    v_mfma_f32_32x32x16_bf16 v[120:135], v[236:239], v[116:119], v[120:135]
    buffer_load_dwordx4 v21, s[32:35], 0 offen lds
    v_exp_f32 v156, v156
    v_exp_f32 v157, v157
    v_exp_f32 v158, v158
    v_exp_f32 v159, v159
    v_smfmac_f32_32x32x32_bf16 v[40:55], v[240:243], v[136:143], v5
    v_mad_i32_i24 v20, v22, 4, v20
    v_exp_f32 v160, v160
    v_exp_f32 v161, v161
    v_exp_f32 v162, v162
    v_exp_f32 v163, v163
    v_smfmac_f32_32x32x32_bf16 v[40:55], v[244:247], v[144:151], v5
    s_waitcnt vmcnt(9)
    v_exp_f32 v164, v164
    v_exp_f32 v165, v165
    v_exp_f32 v166, v166
    v_exp_f32 v167, v167
    v_mfma_f32_32x32x16_bf16 v[136:151], v[168:171], v[88:91], 0
    v_exp_f32 v120, v120
    v_exp_f32 v121, v121
    v_exp_f32 v122, v122
    v_exp_f32 v123, v123
    v_mfma_f32_32x32x16_bf16 v[136:151], v[172:175], v[92:95], v[136:151]
    buffer_load_dwordx4 v[200:203], v19, s[20:23], 0 offen sc1
    v_exp_f32 v124, v124
    v_exp_f32 v125, v125
    v_exp_f32 v126, v126
    v_exp_f32 v127, v127
    v_smfmac_f32_32x32x32_bf16 v[56:71], v[240:243], v[152:159], v5
    s_add_u32 s32, s32, 28672
    s_addc_u32 s33, s33, 0
    v_exp_f32 v128, v128
    v_exp_f32 v129, v129
    v_exp_f32 v130, v130
    v_exp_f32 v131, v131
    v_smfmac_f32_32x32x32_bf16 v[56:71], v[244:247], v[160:167], v5
    s_add_u32 m0, s63, 64512
    v_exp_f32 v132, v132
    v_exp_f32 v133, v133
    v_exp_f32 v134, v134
    v_exp_f32 v135, v135
    v_mfma_f32_32x32x16_bf16 v[152:167], v[168:171], v[96:99], 0
    buffer_load_dwordx4 v21, s[32:35], 0 offen lds
    v_exp_f32 v136, v136
    v_exp_f32 v137, v137
    v_exp_f32 v138, v138
    v_exp_f32 v139, v139
    v_mfma_f32_32x32x16_bf16 v[152:167], v[172:175], v[100:103], v[152:167]
    buffer_load_dwordx4 v[204:207], v19, s[20:23], 0 offen offset:1024 sc1
    v_exp_f32 v140, v140
    v_exp_f32 v141, v141
    v_exp_f32 v142, v142
    v_exp_f32 v143, v143
    v_smfmac_f32_32x32x32_bf16 v[72:87], v[240:243], v[120:127], v5
    s_add_u32 s20, s20, 360960
    s_addc_u32 s21, s21, 0
    v_exp_f32 v144, v144
    v_exp_f32 v145, v145
    v_exp_f32 v146, v146
    v_exp_f32 v147, v147
    v_smfmac_f32_32x32x32_bf16 v[72:87], v[244:247], v[128:135], v5
    s_waitcnt vmcnt(10)
    v_exp_f32 v148, v148
    v_exp_f32 v149, v149
    v_exp_f32 v150, v150
    v_exp_f32 v151, v151
    v_mfma_f32_32x32x16_bf16 v[120:135], v[168:171], v[104:107], 0
    buffer_load_dwordx4 v[208:211], v20, s[12:15], 0 offen sc1
    v_exp_f32 v152, v152
    v_exp_f32 v153, v153
    v_exp_f32 v154, v154
    v_exp_f32 v155, v155
    v_mfma_f32_32x32x16_bf16 v[120:135], v[172:175], v[108:111], v[120:135]
    v_exp_f32 v156, v156
    v_exp_f32 v157, v157
    v_exp_f32 v158, v158
    v_exp_f32 v159, v159
    v_smfmac_f32_32x32x32_bf16 v[24:39], v[176:179], v[136:143], v5
    s_add_u32 s32, s32, 28672
    s_addc_u32 s33, s33, 0
    v_exp_f32 v160, v160
    v_exp_f32 v161, v161
    v_exp_f32 v162, v162
    v_exp_f32 v163, v163
    v_smfmac_f32_32x32x32_bf16 v[24:39], v[180:183], v[144:151], v5
    s_add_u32 m0, s63, 68608
    v_exp_f32 v164, v164
    v_exp_f32 v165, v165
    v_exp_f32 v166, v166
    v_exp_f32 v167, v167
    v_mfma_f32_32x32x16_bf16 v[136:151], v[168:171], v[112:115], 0
    buffer_load_dwordx4 v[212:215], v20, s[24:27], 0 offen sc1
    v_exp_f32 v120, v120
    v_exp_f32 v121, v121
    v_exp_f32 v122, v122
    v_exp_f32 v123, v123
    v_mfma_f32_32x32x16_bf16 v[136:151], v[172:175], v[116:119], v[136:151]
    buffer_load_dwordx4 v21, s[32:35], 0 offen lds
    v_exp_f32 v124, v124
    v_exp_f32 v125, v125
    v_exp_f32 v126, v126
    v_exp_f32 v127, v127
    v_smfmac_f32_32x32x32_bf16 v[40:55], v[176:179], v[152:159], v5
    v_mad_i32_i24 v20, v22, 4, v20
    v_exp_f32 v128, v128
    v_exp_f32 v129, v129
    v_exp_f32 v130, v130
    v_exp_f32 v131, v131
    v_smfmac_f32_32x32x32_bf16 v[40:55], v[180:183], v[160:167], v5
    s_waitcnt vmcnt(9)
    v_exp_f32 v132, v132
    v_exp_f32 v133, v133
    v_exp_f32 v134, v134
    v_exp_f32 v135, v135
    v_mfma_f32_32x32x16_bf16 v[152:167], v[184:187], v[88:91], 0
    v_exp_f32 v136, v136
    v_exp_f32 v137, v137
    v_exp_f32 v138, v138
    v_exp_f32 v139, v139
    v_mfma_f32_32x32x16_bf16 v[152:167], v[188:191], v[92:95], v[152:167]
    buffer_load_dwordx4 v[216:219], v19, s[20:23], 0 offen sc1
    v_exp_f32 v140, v140
    v_exp_f32 v141, v141
    v_exp_f32 v142, v142
    v_exp_f32 v143, v143
    v_smfmac_f32_32x32x32_bf16 v[56:71], v[176:179], v[120:127], v5
    buffer_load_dwordx4 v[220:223], v19, s[20:23], 0 offen offset:1024 sc1
    v_exp_f32 v144, v144
    v_exp_f32 v145, v145
    v_exp_f32 v146, v146
    v_exp_f32 v147, v147
    v_smfmac_f32_32x32x32_bf16 v[56:71], v[180:183], v[128:135], v5
    s_cmp_eq_u32 s67, 4
    s_cselect_b32 s43, -52, 4
    s_cselect_b32 s49, -1, 0
    s_mul_i32 s45, s43, 90240
    v_exp_f32 v148, v148
    v_exp_f32 v149, v149
    v_exp_f32 v150, v150
    v_exp_f32 v151, v151
    v_mfma_f32_32x32x16_bf16 v[120:135], v[184:187], v[96:99], 0
    buffer_load_dwordx4 v[224:227], v20, s[12:15], 0 offen sc1
    v_exp_f32 v152, v152
    v_exp_f32 v153, v153
    v_exp_f32 v154, v154
    v_exp_f32 v155, v155
    v_mfma_f32_32x32x16_bf16 v[120:135], v[188:191], v[100:103], v[120:135]
    buffer_load_dwordx4 v[228:231], v20, s[24:27], 0 offen sc1
    v_exp_f32 v156, v156
    v_exp_f32 v157, v157
    v_exp_f32 v158, v158
    v_exp_f32 v159, v159
    v_smfmac_f32_32x32x32_bf16 v[72:87], v[176:179], v[136:143], v5
    s_add_u32 s20, s20, s45
    s_addc_u32 s21, s21, s49
    v_mad_i32_i24 v20, v22, s43, v20
    v_exp_f32 v160, v160
    v_exp_f32 v161, v161
    v_exp_f32 v162, v162
    v_exp_f32 v163, v163
    v_smfmac_f32_32x32x32_bf16 v[72:87], v[180:183], v[144:151], v5
    s_waitcnt vmcnt(11)
    v_exp_f32 v164, v164
    v_exp_f32 v165, v165
    v_exp_f32 v166, v166
    v_exp_f32 v167, v167
    v_mfma_f32_32x32x16_bf16 v[136:151], v[184:187], v[104:107], 0
    v_exp_f32 v120, v120
    v_exp_f32 v121, v121
    v_exp_f32 v122, v122
    v_exp_f32 v123, v123
    v_mfma_f32_32x32x16_bf16 v[136:151], v[188:191], v[108:111], v[136:151]
    buffer_load_dwordx4 v[232:235], v19, s[20:23], 0 offen sc1
    v_exp_f32 v124, v124
    v_exp_f32 v125, v125
    v_exp_f32 v126, v126
    v_exp_f32 v127, v127
    v_smfmac_f32_32x32x32_bf16 v[24:39], v[192:195], v[152:159], v5
    buffer_load_dwordx4 v[236:239], v19, s[20:23], 0 offen offset:1024 sc1
    v_exp_f32 v128, v128
    v_exp_f32 v129, v129
    v_exp_f32 v130, v130
    v_exp_f32 v131, v131
    v_smfmac_f32_32x32x32_bf16 v[24:39], v[196:199], v[160:167], v5
    s_add_u32 s32, s32, 28672
    s_addc_u32 s33, s33, 0
    v_exp_f32 v132, v132
    v_exp_f32 v133, v133
    v_exp_f32 v134, v134
    v_exp_f32 v135, v135
    v_mfma_f32_32x32x16_bf16 v[152:167], v[184:187], v[112:115], 0
    buffer_load_dwordx4 v[240:243], v20, s[12:15], 0 offen sc1
    v_exp_f32 v136, v136
    v_exp_f32 v137, v137
    v_exp_f32 v138, v138
    v_exp_f32 v139, v139
    v_mfma_f32_32x32x16_bf16 v[152:167], v[188:191], v[116:119], v[152:167]
    buffer_load_dwordx4 v[244:247], v20, s[24:27], 0 offen sc1
    v_exp_f32 v140, v140
    v_exp_f32 v141, v141
    v_exp_f32 v142, v142
    v_exp_f32 v143, v143
    v_smfmac_f32_32x32x32_bf16 v[40:55], v[192:195], v[120:127], v5
    s_add_u32 s20, s20, 360960
    s_addc_u32 s21, s21, 0
    v_mad_i32_i24 v20, v22, 4, v20
    v_exp_f32 v144, v144
    v_exp_f32 v145, v145
    v_exp_f32 v146, v146
    v_exp_f32 v147, v147
    v_smfmac_f32_32x32x32_bf16 v[40:55], v[196:199], v[128:135], v5
    s_waitcnt vmcnt(11)
    s_add_u32 m0, s63, 72704
    v_exp_f32 v148, v148
    v_exp_f32 v149, v149
    v_exp_f32 v150, v150
    v_exp_f32 v151, v151
    v_mfma_f32_32x32x16_bf16 v[120:135], v[200:203], v[88:91], 0
    buffer_load_dwordx4 v21, s[32:35], 0 offen lds
    v_exp_f32 v152, v152
    v_exp_f32 v153, v153
    v_exp_f32 v154, v154
    v_exp_f32 v155, v155
    v_mfma_f32_32x32x16_bf16 v[120:135], v[204:207], v[92:95], v[120:135]
    buffer_load_dwordx4 v[168:171], v19, s[20:23], 0 offen sc1
    v_exp_f32 v156, v156
    v_exp_f32 v157, v157
    v_exp_f32 v158, v158
    v_exp_f32 v159, v159
    v_smfmac_f32_32x32x32_bf16 v[56:71], v[192:195], v[136:143], v5
    buffer_load_dwordx4 v[172:175], v19, s[20:23], 0 offen offset:1024 sc1
    v_exp_f32 v160, v160
    v_exp_f32 v161, v161
    v_exp_f32 v162, v162
    v_exp_f32 v163, v163
    v_smfmac_f32_32x32x32_bf16 v[56:71], v[196:199], v[144:151], v5
    s_add_u32 s32, s32, 28672
    s_addc_u32 s33, s33, 0
    v_exp_f32 v164, v164
    v_exp_f32 v165, v165
    v_exp_f32 v166, v166
    v_exp_f32 v167, v167
    s_branch L_pg_B4
.p2align 12
L_stub_B4:
    s_branch L_backB
    s_nop 0
L_pg_B4:
    v_mfma_f32_32x32x16_bf16 v[136:151], v[200:203], v[96:99], 0
    buffer_load_dwordx4 v[176:179], v20, s[12:15], 0 offen sc1
    v_exp_f32 v120, v120
    v_exp_f32 v121, v121
    v_exp_f32 v122, v122
    v_exp_f32 v123, v123
    v_mfma_f32_32x32x16_bf16 v[136:151], v[204:207], v[100:103], v[136:151]
    buffer_load_dwordx4 v[180:183], v20, s[24:27], 0 offen sc1
    v_exp_f32 v124, v124
    v_exp_f32 v125, v125
    v_exp_f32 v126, v126
    v_exp_f32 v127, v127
    v_smfmac_f32_32x32x32_bf16 v[72:87], v[192:195], v[152:159], v5
    s_add_u32 m0, s63, 76800
    s_mov_b32 s61, 0x33800000
    v_exp_f32 v128, v128
    v_exp_f32 v129, v129
    v_exp_f32 v130, v130
    v_exp_f32 v131, v131
    v_smfmac_f32_32x32x32_bf16 v[72:87], v[196:199], v[160:167], v5
    s_waitcnt vmcnt(14)
    v_exp_f32 v132, v132
    v_exp_f32 v133, v133
    v_exp_f32 v134, v134
    v_exp_f32 v135, v135
    v_mfma_f32_32x32x16_bf16 v[152:167], v[200:203], v[104:107], 0
    buffer_load_dwordx4 v21, s[32:35], 0 offen lds
    v_exp_f32 v136, v136
    v_exp_f32 v137, v137
    v_exp_f32 v138, v138
    v_exp_f32 v139, v139
    v_mfma_f32_32x32x16_bf16 v[152:167], v[204:207], v[108:111], v[152:167]
    s_movk_i32 s43, 0x1f8
    v_exp_f32 v140, v140
    v_exp_f32 v141, v141
    v_exp_f32 v142, v142
    v_exp_f32 v143, v143
    v_smfmac_f32_32x32x32_bf16 v[24:39], v[208:211], v[120:127], v5
    s_mov_b32 s62, 0x53800000
    v_exp_f32 v144, v144
    v_exp_f32 v145, v145
    v_exp_f32 v146, v146
    v_exp_f32 v147, v147
    v_smfmac_f32_32x32x32_bf16 v[24:39], v[212:215], v[128:135], v5
    v_exp_f32 v148, v148
    v_exp_f32 v149, v149
    v_exp_f32 v150, v150
    v_exp_f32 v151, v151
    v_mfma_f32_32x32x16_bf16 v[120:135], v[200:203], v[112:115], 0
    v_exp_f32 v152, v152
    v_exp_f32 v153, v153
    v_exp_f32 v154, v154
    v_exp_f32 v155, v155
    v_mfma_f32_32x32x16_bf16 v[120:135], v[204:207], v[116:119], v[120:135]
    v_exp_f32 v156, v156
    v_exp_f32 v157, v157
    v_exp_f32 v158, v158
    v_exp_f32 v159, v159
    v_smfmac_f32_32x32x32_bf16 v[40:55], v[208:211], v[136:143], v5
    v_exp_f32 v160, v160
    v_exp_f32 v161, v161
    v_exp_f32 v162, v162
    v_exp_f32 v163, v163
    v_smfmac_f32_32x32x32_bf16 v[40:55], v[212:215], v[144:151], v5
    s_waitcnt vmcnt(12)
    v_exp_f32 v164, v164
    v_exp_f32 v165, v165
    v_exp_f32 v166, v166
    v_exp_f32 v167, v167
    v_mfma_f32_32x32x16_bf16 v[136:151], v[216:219], v[88:91], 0
    v_exp_f32 v120, v120
    v_exp_f32 v121, v121
    v_exp_f32 v122, v122
    v_exp_f32 v123, v123
    v_mfma_f32_32x32x16_bf16 v[136:151], v[220:223], v[92:95], v[136:151]
    v_exp_f32 v124, v124
    v_exp_f32 v125, v125
    v_exp_f32 v126, v126
    v_exp_f32 v127, v127
    v_smfmac_f32_32x32x32_bf16 v[56:71], v[208:211], v[152:159], v5
    v_exp_f32 v128, v128
    v_exp_f32 v129, v129
    v_exp_f32 v130, v130
    v_exp_f32 v131, v131
    v_smfmac_f32_32x32x32_bf16 v[56:71], v[212:215], v[160:167], v5
    s_waitcnt vmcnt(8)
    v_exp_f32 v132, v132
    v_exp_f32 v133, v133
    v_exp_f32 v134, v134
    v_exp_f32 v135, v135
    v_mfma_f32_32x32x16_bf16 v[152:167], v[232:235], v[88:91], 0
    v_exp_f32 v136, v136
    v_exp_f32 v137, v137
    v_exp_f32 v138, v138
    v_exp_f32 v139, v139
    v_mfma_f32_32x32x16_bf16 v[152:167], v[236:239], v[92:95], v[152:167]
    v_exp_f32 v140, v140
    v_exp_f32 v141, v141
    v_exp_f32 v142, v142
    v_exp_f32 v143, v143
    v_smfmac_f32_32x32x32_bf16 v[72:87], v[208:211], v[120:127], v5
    v_exp_f32 v144, v144
    v_exp_f32 v145, v145
    v_exp_f32 v146, v146
    v_exp_f32 v147, v147
    v_smfmac_f32_32x32x32_bf16 v[72:87], v[212:215], v[128:135], v5
    s_waitcnt vmcnt(10)
    s_waitcnt vmcnt(3)
    v_exp_f32 v148, v148
    v_exp_f32 v149, v149
    v_exp_f32 v150, v150
    v_exp_f32 v151, v151
    v_mfma_f32_32x32x16_bf16 v[120:135], v[168:171], v[88:91], 0
    v_exp_f32 v152, v152
    v_exp_f32 v153, v153
    v_exp_f32 v154, v154
    v_exp_f32 v155, v155
    v_mfma_f32_32x32x16_bf16 v[120:135], v[172:175], v[92:95], v[120:135]
    v_exp_f32 v156, v156
    v_exp_f32 v157, v157
    v_exp_f32 v158, v158
    v_exp_f32 v159, v159
    v_smfmac_f32_32x32x32_bf16 v[24:39], v[224:227], v[136:143], v5
    v_exp_f32 v160, v160
    v_exp_f32 v161, v161
    v_exp_f32 v162, v162
    v_exp_f32 v163, v163
    v_smfmac_f32_32x32x32_bf16 v[24:39], v[228:231], v[144:151], v5
    s_waitcnt vmcnt(6)
    v_exp_f32 v164, v164
    v_exp_f32 v165, v165
    v_exp_f32 v166, v166
    v_exp_f32 v167, v167
    v_mfma_f32_32x32x16_bf16 v[136:151], v[216:219], v[96:99], 0
    v_exp_f32 v120, v120
    v_exp_f32 v121, v121
    v_exp_f32 v122, v122
    v_exp_f32 v123, v123
    v_mfma_f32_32x32x16_bf16 v[136:151], v[220:223], v[100:103], v[136:151]
    v_exp_f32 v124, v124
    v_exp_f32 v125, v125
    v_exp_f32 v126, v126
    v_exp_f32 v127, v127
    v_smfmac_f32_32x32x32_bf16 v[24:39], v[240:243], v[152:159], v5
    v_exp_f32 v128, v128
    v_exp_f32 v129, v129
    v_exp_f32 v130, v130
    v_exp_f32 v131, v131
    v_smfmac_f32_32x32x32_bf16 v[24:39], v[244:247], v[160:167], v5
    s_waitcnt vmcnt(1)
    v_exp_f32 v132, v132
    v_exp_f32 v133, v133
    v_exp_f32 v134, v134
    v_exp_f32 v135, v135
    v_mfma_f32_32x32x16_bf16 v[152:167], v[232:235], v[96:99], 0
    v_exp_f32 v136, v136
    v_exp_f32 v137, v137
    v_exp_f32 v138, v138
    v_exp_f32 v139, v139
    v_mfma_f32_32x32x16_bf16 v[152:167], v[236:239], v[100:103], v[152:167]
    v_exp_f32 v140, v140
    v_exp_f32 v141, v141
    v_exp_f32 v142, v142
    v_exp_f32 v143, v143
    v_smfmac_f32_32x32x32_bf16 v[24:39], v[176:179], v[120:127], v5
    v_exp_f32 v144, v144
    v_exp_f32 v145, v145
    v_exp_f32 v146, v146
    v_exp_f32 v147, v147
    v_smfmac_f32_32x32x32_bf16 v[24:39], v[180:183], v[128:135], v5
    v_exp_f32 v148, v148
    v_exp_f32 v149, v149
    v_exp_f32 v150, v150
    v_exp_f32 v151, v151
    v_mfma_f32_32x32x16_bf16 v[120:135], v[168:171], v[96:99], 0
    v_exp_f32 v152, v152
    v_exp_f32 v153, v153
    v_exp_f32 v154, v154
    v_exp_f32 v155, v155
    v_mfma_f32_32x32x16_bf16 v[120:135], v[172:175], v[100:103], v[120:135]
    v_exp_f32 v156, v156
    v_exp_f32 v157, v157
    v_exp_f32 v158, v158
    v_exp_f32 v159, v159
    v_smfmac_f32_32x32x32_bf16 v[40:55], v[224:227], v[136:143], v5
    ds_write_b128 v252, v[24:27] offset:0
    v_exp_f32 v160, v160
    v_exp_f32 v161, v161
    v_exp_f32 v162, v162
    v_exp_f32 v163, v163
    v_smfmac_f32_32x32x32_bf16 v[40:55], v[228:231], v[144:151], v5
    ds_write_b128 v252, v[28:31] offset:1024
    v_exp_f32 v164, v164
    v_exp_f32 v165, v165
    v_exp_f32 v166, v166
    v_exp_f32 v167, v167
    v_mfma_f32_32x32x16_bf16 v[136:151], v[216:219], v[104:107], 0
    ds_write_b128 v252, v[32:35] offset:2048
    v_exp_f32 v120, v120
    v_exp_f32 v121, v121
    v_exp_f32 v122, v122
    v_exp_f32 v123, v123
    v_mfma_f32_32x32x16_bf16 v[136:151], v[220:223], v[108:111], v[136:151]
    ds_write_b128 v252, v[36:39] offset:3072
    v_exp_f32 v124, v124
    v_exp_f32 v125, v125
    v_exp_f32 v126, v126
    v_exp_f32 v127, v127
    v_smfmac_f32_32x32x32_bf16 v[40:55], v[240:243], v[152:159], v5
    s_waitcnt vmcnt(0)
    v_exp_f32 v128, v128
    v_exp_f32 v129, v129
    v_exp_f32 v130, v130
    v_exp_f32 v131, v131
    v_smfmac_f32_32x32x32_bf16 v[40:55], v[244:247], v[160:167], v5
    s_waitcnt lgkmcnt(0)
    s_barrier
    v_exp_f32 v132, v132
    v_exp_f32 v133, v133
    v_exp_f32 v134, v134
    v_exp_f32 v135, v135
    v_mfma_f32_32x32x16_bf16 v[152:167], v[232:235], v[104:107], 0
    ds_read_b128 v[28:31], v255 offset:1024
    v_exp_f32 v136, v136
    v_exp_f32 v137, v137
    v_exp_f32 v138, v138
    v_exp_f32 v139, v139
    v_mfma_f32_32x32x16_bf16 v[152:167], v[236:239], v[108:111], v[152:167]
    ds_read_b128 v[24:27], v255 offset:0
    v_exp_f32 v140, v140
    v_exp_f32 v141, v141
    v_exp_f32 v142, v142
    v_exp_f32 v143, v143
    v_smfmac_f32_32x32x32_bf16 v[40:55], v[176:179], v[120:127], v5
    ds_read_b128 v[32:35], v255 offset:2048
    v_exp_f32 v144, v144
    v_exp_f32 v145, v145
    v_exp_f32 v146, v146
    v_exp_f32 v147, v147
    v_smfmac_f32_32x32x32_bf16 v[40:55], v[180:183], v[128:135], v5
    ds_read_b128 v[36:39], v255 offset:3072
    v_exp_f32 v148, v148
    v_exp_f32 v149, v149
    v_exp_f32 v150, v150
    v_exp_f32 v151, v151
    v_mfma_f32_32x32x16_bf16 v[120:135], v[168:171], v[104:107], 0
    v_exp_f32 v152, v152
    v_exp_f32 v153, v153
    v_exp_f32 v154, v154
    v_exp_f32 v155, v155
    v_mfma_f32_32x32x16_bf16 v[120:135], v[172:175], v[108:111], v[120:135]
    s_waitcnt lgkmcnt(0)
    s_barrier
    v_exp_f32 v156, v156
    v_exp_f32 v157, v157
    v_exp_f32 v158, v158
    v_exp_f32 v159, v159
    v_smfmac_f32_32x32x32_bf16 v[56:71], v[224:227], v[136:143], v5
    ds_write_b128 v253, v[40:43] offset:0
    v_exp_f32 v160, v160
    v_exp_f32 v161, v161
    v_exp_f32 v162, v162
    v_exp_f32 v163, v163
    v_smfmac_f32_32x32x32_bf16 v[56:71], v[228:231], v[144:151], v5
    ds_write_b128 v253, v[44:47] offset:1024
    v_exp_f32 v164, v164
    v_exp_f32 v165, v165
    v_exp_f32 v166, v166
    v_exp_f32 v167, v167
    v_mfma_f32_32x32x16_bf16 v[136:151], v[216:219], v[112:115], 0
    ds_write_b128 v253, v[48:51] offset:2048
    v_exp_f32 v120, v120
    v_exp_f32 v121, v121
    v_exp_f32 v122, v122
    v_exp_f32 v123, v123
    v_mfma_f32_32x32x16_bf16 v[136:151], v[220:223], v[116:119], v[136:151]
    ds_write_b128 v253, v[52:55] offset:3072
    v_exp_f32 v124, v124
    v_exp_f32 v125, v125
    v_exp_f32 v126, v126
    v_exp_f32 v127, v127
    v_smfmac_f32_32x32x32_bf16 v[56:71], v[240:243], v[152:159], v5
    v_exp_f32 v128, v128
    v_exp_f32 v129, v129
    v_exp_f32 v130, v130
    v_exp_f32 v131, v131
    v_smfmac_f32_32x32x32_bf16 v[56:71], v[244:247], v[160:167], v5
    s_waitcnt lgkmcnt(0)
    s_barrier
    v_exp_f32 v132, v132
    v_exp_f32 v133, v133
    v_exp_f32 v134, v134
    v_exp_f32 v135, v135
    v_mfma_f32_32x32x16_bf16 v[152:167], v[232:235], v[112:115], 0
    ds_read_b128 v[44:47], v255 offset:1024
    v_exp_f32 v136, v136
    v_exp_f32 v137, v137
    v_exp_f32 v138, v138
    v_exp_f32 v139, v139
    v_mfma_f32_32x32x16_bf16 v[152:167], v[236:239], v[116:119], v[152:167]
    ds_read_b128 v[40:43], v255 offset:0
    v_exp_f32 v140, v140
    v_exp_f32 v141, v141
    v_exp_f32 v142, v142
    v_exp_f32 v143, v143
    v_smfmac_f32_32x32x32_bf16 v[56:71], v[176:179], v[120:127], v5
    ds_read_b128 v[48:51], v255 offset:2048
    v_exp_f32 v144, v144
    v_exp_f32 v145, v145
    v_exp_f32 v146, v146
    v_exp_f32 v147, v147
    v_smfmac_f32_32x32x32_bf16 v[56:71], v[180:183], v[128:135], v5
    ds_read_b128 v[52:55], v255 offset:3072
    v_exp_f32 v148, v148
    v_exp_f32 v149, v149
    v_exp_f32 v150, v150
    v_exp_f32 v151, v151
    v_mfma_f32_32x32x16_bf16 v[120:135], v[168:171], v[112:115], 0
    v_exp_f32 v152, v152
    v_exp_f32 v153, v153
    v_exp_f32 v154, v154
    v_exp_f32 v155, v155
    v_mfma_f32_32x32x16_bf16 v[120:135], v[172:175], v[116:119], v[120:135]
    s_waitcnt lgkmcnt(0)
    s_barrier
    buffer_store_dword v6, v23, s[12:15], s44 offen sc1
    v_exp_f32 v156, v156
    v_exp_f32 v157, v157
    v_exp_f32 v158, v158
    v_exp_f32 v159, v159
    v_smfmac_f32_32x32x32_bf16 v[72:87], v[224:227], v[136:143], v5
    ds_write_b128 v254, v[56:59] offset:0
    v_exp_f32 v160, v160
    v_exp_f32 v161, v161
    v_exp_f32 v162, v162
    v_exp_f32 v163, v163
    v_smfmac_f32_32x32x32_bf16 v[72:87], v[228:231], v[144:151], v5
    ds_write_b128 v254, v[60:63] offset:1024
    v_exp_f32 v164, v164
    v_exp_f32 v165, v165
    v_exp_f32 v166, v166
    v_exp_f32 v167, v167
    v_smfmac_f32_32x32x32_bf16 v[72:87], v[240:243], v[152:159], v5
    ds_write_b128 v254, v[64:67] offset:2048
    v_exp_f32 v120, v120
    v_exp_f32 v121, v121
    v_exp_f32 v122, v122
    v_exp_f32 v123, v123
    v_smfmac_f32_32x32x32_bf16 v[72:87], v[244:247], v[160:167], v5
    ds_write_b128 v254, v[68:71] offset:3072
    v_exp_f32 v124, v124
    v_exp_f32 v125, v125
    v_exp_f32 v126, v126
    v_exp_f32 v127, v127
    v_exp_f32 v128, v128
    v_exp_f32 v129, v129
    v_exp_f32 v130, v130
    v_exp_f32 v131, v131
    v_smfmac_f32_32x32x32_bf16 v[72:87], v[176:179], v[120:127], v5
    s_waitcnt lgkmcnt(0)
    s_barrier
    ds_read_b128 v[60:63], v255 offset:1024
    ds_read_b128 v[56:59], v255 offset:0
    ds_read_b128 v[64:67], v255 offset:2048
    ds_read_b128 v[68:71], v255 offset:3072
    v_exp_f32 v132, v132
    v_exp_f32 v133, v133
    v_exp_f32 v134, v134
    v_exp_f32 v135, v135
    s_nop 1
    v_smfmac_f32_32x32x32_bf16 v[72:87], v[180:183], v[128:135], v5
    v_add_f32 v24, v24, v40
    v_add_f32 v25, v25, v41
    v_add_f32 v26, v26, v42
    v_add_f32 v27, v27, v43
    v_add_f32 v28, v28, v44
    v_add_f32 v29, v29, v45
    v_add_f32 v30, v30, v46
    v_add_f32 v31, v31, v47
    v_add_f32 v32, v32, v48
    v_add_f32 v33, v33, v49
    v_add_f32 v34, v34, v50
    v_add_f32 v35, v35, v51
    v_add_f32 v36, v36, v52
    v_add_f32 v37, v37, v53
    v_add_f32 v38, v38, v54
    s_waitcnt lgkmcnt(0)
    v_pk_add_f32 v[76:77], v[76:77], v[28:29]
    v_pk_add_f32 v[78:79], v[78:79], v[30:31]
    v_pk_add_f32 v[76:77], v[76:77], v[60:61]
    v_pk_add_f32 v[78:79], v[78:79], v[62:63]
    v_rcp_f32 v20, v79
    v_cmp_le_f32 s[54:55], s61, v79
    v_cmp_ge_f32 vcc, s62, v79
    v_pk_add_f32 v[8:9], v[76:77], v[78:79]
    v_pk_add_f32 v[72:73], v[72:73], v[24:25]
    v_pk_add_f32 v[74:75], v[74:75], v[26:27]
    v_pk_add_f32 v[72:73], v[72:73], v[56:57]
    v_pk_add_f32 v[74:75], v[74:75], v[58:59]
    v_pk_add_f32 v[8:9], v[8:9], v[72:73]
    v_pk_add_f32 v[8:9], v[8:9], v[74:75]
    s_and_b64 s[54:55], s[54:55], vcc
    v_pk_add_f32 v[80:81], v[80:81], v[32:33]
    v_pk_add_f32 v[82:83], v[82:83], v[34:35]
    v_pk_add_f32 v[80:81], v[80:81], v[64:65]
    v_pk_add_f32 v[82:83], v[82:83], v[66:67]
    v_pk_add_f32 v[8:9], v[8:9], v[80:81]
    v_pk_add_f32 v[8:9], v[8:9], v[82:83]
    v_pk_add_f32 v[84:85], v[84:85], v[36:37]
    v_pk_add_f32 v[86:87], v[86:87], v[38:39]
    v_pk_add_f32 v[84:85], v[84:85], v[68:69]
    v_pk_add_f32 v[86:87], v[86:87], v[70:71]
    v_pk_add_f32 v[8:9], v[8:9], v[84:85]
    v_pk_add_f32 v[8:9], v[8:9], v[86:87]
    v_add_f32 v8, v8, v9
    v_cmp_class_f32 vcc, v8, s43
    v_pk_mul_f32 v[72:73], v[72:73], v[20:21] op_sel_hi:[1,0]
    v_pk_mul_f32 v[74:75], v[74:75], v[20:21] op_sel_hi:[1,0]
    v_pk_mul_f32 v[76:77], v[76:77], v[20:21] op_sel_hi:[1,0]
    v_pk_mul_f32 v[78:79], v[78:79], v[20:21] op_sel_hi:[1,0]
    v_cvt_pk_bf16_f32 v24, v72, v73
    v_cvt_pk_bf16_f32 v25, v74, v75
    v_cvt_pk_bf16_f32 v26, v76, v77
    v_cvt_pk_bf16_f32 v27, v78, s53
    s_and_b64 s[54:55], s[54:55], vcc
    s_cmp_eq_u64 s[54:55], -1
    s_cbranch_scc0 L_slow
L_checked:
    buffer_store_dwordx4 v[24:27], v250, s[12:15], s66 offen sc1
    v_pk_mul_f32 v[80:81], v[80:81], v[20:21] op_sel_hi:[1,0]
    v_pk_mul_f32 v[82:83], v[82:83], v[20:21] op_sel_hi:[1,0]
    v_pk_mul_f32 v[84:85], v[84:85], v[20:21] op_sel_hi:[1,0]
    v_pk_mul_f32 v[86:87], v[86:87], v[20:21] op_sel_hi:[1,0]
    v_cvt_pk_bf16_f32 v28, v80, v81
    v_cvt_pk_bf16_f32 v29, v82, v83
    v_cvt_pk_bf16_f32 v30, v84, v85
    v_cvt_pk_bf16_f32 v31, v86, s53
    buffer_store_dwordx4 v[28:31], v250, s[12:15], s66 offen offset:1024 sc1
    s_cmp_eq_u32 s31, 7
    s_cbranch_scc1 L_nojob
    v_bfe_u32 v19, v1, 2, 2
    v_mad_u32_u24 v20, v18, 7, v19
    v_and_b32 v21, 1, v1
    v_bfe_u32 v22, v1, 1, 1
    v_lshl_add_u32 v21, v21, 2, v22
    v_bfe_u32 v22, v1, 4, 1
    v_lshl_add_u32 v21, v22, 1, v21
    v_lshlrev_b32 v21, 3, v21
    s_and_b32 s62, s16, 1
    v_bfe_u32 v19, v20, 1, 1
    v_xor_b32 v19, s62, v19
    v_lshl_add_u32 v21, v19, 6, v21
    v_lshl_add_u32 v3, v20, 7, v21
    v_add_u32 v3, 23552, v3
    v_xor_b32 v2, 64, v3
    s_branch L_pg_B5
.p2align 12
L_stub_B5:
    s_branch L_backA
    s_nop 0
L_pg_B5:
    s_lshl_b32 s62, s30, 11
    s_add_u32 s62, s62, 36864
    v_lshl_add_u32 v6, v1, 7, s62
    s_mov_b64 s[54:55], 0xffff
    s_bitset0_b32 s54, s17
    s_cmp_lg_u32 s16, 1
    s_cbranch_scc1 L_nopoll_11
    v_mov_b32 v7, 0
    s_mov_b64 exec, s[54:55]
    buffer_atomic_or v7, v6, s[12:15], 0 offen sc0
    s_mov_b64 exec, -1
L_nopoll_11:
    ds_read_b64_tr_b16 v[32:33], v3 offset:0
    s_lshr_b32 s62, s16, 1
    ds_read_b64_tr_b16 v[34:35], v3 offset:512
    s_lshl_b32 s62, s62, 13
    ds_read_b64_tr_b16 v[36:37], v2 offset:1792
    v_add_u32 v4, s62, v250
    ds_read_b64_tr_b16 v[38:39], v2 offset:2304
    s_lshl_b32 s44, s30, 2
    ds_read_b64_tr_b16 v[40:41], v3 offset:3584
    s_lshl_b32 s62, s40, 1
    ds_read_b64_tr_b16 v[42:43], v3 offset:4096
    s_add_u32 s44, s44, s62
    ds_read_b64_tr_b16 v[44:45], v2 offset:5376
    s_lshr_b32 s62, s16, 1
    ds_read_b64_tr_b16 v[46:47], v2 offset:5888
    s_add_u32 s64, s44, s62
    ds_read_b64_tr_b16 v[48:49], v3 offset:7168
    s_mul_i32 s44, s64, 90240
    ds_read_b64_tr_b16 v[50:51], v3 offset:7680
    s_add_u32 s50, s44, 647168
    ds_read_b64_tr_b16 v[52:53], v2 offset:8960
    s_and_b32 s62, s16, 1
    ds_read_b64_tr_b16 v[54:55], v2 offset:9472
    s_lshl_b32 s62, s62, 12
    ds_read_b64_tr_b16 v[56:57], v3 offset:10752
    s_add_u32 s44, s50, s62
    ds_read_b64_tr_b16 v[58:59], v3 offset:11264
    s_add_u32 s45, s44, 8192
    ds_read_b64_tr_b16 v[60:61], v2 offset:12544
    s_add_u32 s46, s44, 16384
    ds_read_b64_tr_b16 v[62:63], v2 offset:13056
    s_add_u32 s47, s44, 24576
    ds_read_b64_tr_b16 v[64:65], v3 offset:14336
    s_mul_i32 s62, s16, 2560
    ds_read_b64_tr_b16 v[66:67], v3 offset:14848
    s_add_u32 s62, s62, 65536
    ds_read_b64_tr_b16 v[68:69], v2 offset:16128
    v_mul_u32_u24 v8, 80, v17
    ds_read_b64_tr_b16 v[70:71], v2 offset:16640
    v_lshl_add_u32 v8, v18, 5, v8
    ds_read_b64_tr_b16 v[72:73], v3 offset:17920
    v_add_u32 v8, s62, v8
    ds_read_b64_tr_b16 v[74:75], v3 offset:18432
    v_lshrrev_b32 v17, 2, v1
    ds_read_b64_tr_b16 v[76:77], v2 offset:19712
    v_and_b32 v19, 3, v1
    ds_read_b64_tr_b16 v[78:79], v2 offset:20224
    v_mul_u32_u24 v9, 80, v17
    ds_read_b64_tr_b16 v[80:81], v3 offset:21504
    v_lshl_add_u32 v9, v19, 4, v9
    ds_read_b64_tr_b16 v[82:83], v3 offset:22016
    v_add_u32 v9, s62, v9
    ds_read_b64_tr_b16 v[84:85], v2 offset:23296
    v_mul_u32_u24 v10, 1792, v17
    ds_read_b64_tr_b16 v[86:87], v2 offset:23808
    v_lshl_add_u32 v10, v19, 4, v10
    ds_read_b64_tr_b16 v[88:89], v3 offset:25088
    s_mul_i32 s48, s64, 57344
    ds_read_b64_tr_b16 v[90:91], v3 offset:25600
    s_lshl_b32 s62, s31, 7
    ds_read_b64_tr_b16 v[92:93], v2 offset:26880
    s_add_u32 s48, s48, s62
    ds_read_b64_tr_b16 v[94:95], v2 offset:27392
    s_and_b32 s62, s16, 1
    ds_read_b64_tr_b16 v[96:97], v3 offset:28672
    s_lshl_b32 s62, s62, 6
    ds_read_b64_tr_b16 v[98:99], v3 offset:29184
    s_add_u32 s48, s48, s62
    ds_read_b64_tr_b16 v[100:101], v2 offset:30464
    s_add_u32 s48, s48, 896
    ds_read_b64_tr_b16 v[102:103], v2 offset:30976
    s_add_u32 s51, s48, 28672
    ds_read_b64_tr_b16 v[104:105], v3 offset:32256
    v_mov_b32 v5, 0
    ds_read_b64_tr_b16 v[106:107], v3 offset:32768
    ds_read_b64_tr_b16 v[108:109], v2 offset:34048
    ds_read_b64_tr_b16 v[110:111], v2 offset:34560
    ds_read_b64_tr_b16 v[112:113], v3 offset:35840
    ds_read_b64_tr_b16 v[114:115], v3 offset:36352
    ds_read_b64_tr_b16 v[116:117], v2 offset:37632
    ds_read_b64_tr_b16 v[118:119], v2 offset:38144
    ds_read_b64_tr_b16 v[120:121], v3 offset:39424
    ds_read_b64_tr_b16 v[122:123], v3 offset:39936
    ds_read_b64_tr_b16 v[124:125], v2 offset:41216
    ds_read_b64_tr_b16 v[126:127], v2 offset:41728
    ds_read_b64_tr_b16 v[128:129], v3 offset:43008
    ds_read_b64_tr_b16 v[130:131], v3 offset:43520
    ds_read_b64_tr_b16 v[132:133], v2 offset:44800
    ds_read_b64_tr_b16 v[134:135], v2 offset:45312
    ds_read_b64_tr_b16 v[136:137], v3 offset:46592
    ds_read_b64_tr_b16 v[138:139], v3 offset:47104
    ds_read_b64_tr_b16 v[140:141], v2 offset:48384
    ds_read_b64_tr_b16 v[142:143], v2 offset:48896
    ds_read_b64_tr_b16 v[144:145], v3 offset:50176
    ds_read_b64_tr_b16 v[146:147], v3 offset:50688
    ds_read_b64_tr_b16 v[148:149], v2 offset:51968
    ds_read_b64_tr_b16 v[150:151], v2 offset:52480
    ds_read_b64_tr_b16 v[152:153], v3 offset:53760
    ds_read_b64_tr_b16 v[154:155], v3 offset:54272
    ds_read_b64_tr_b16 v[156:157], v2 offset:55552
    ds_read_b64_tr_b16 v[158:159], v2 offset:56064
    s_cmp_lg_u32 s16, 1
    s_cbranch_scc1 L_nopoll_12
    s_mov_b32 s58, 40000
    s_mov_b64 exec, s[54:55]
L_poll_13:
    v_mov_b32 v11, 0
    buffer_atomic_or v11, v6, s[12:15], 0 offen sc0
    s_waitcnt vmcnt(1)
    v_cmp_ne_u32 vcc, s41, v7
    s_nop 1
    s_cbranch_vccz L_polldone_14
    v_mov_b32 v7, 0
    buffer_atomic_or v7, v6, s[12:15], 0 offen sc0
    s_waitcnt vmcnt(1)
    v_cmp_ne_u32 vcc, s41, v11
    s_nop 1
    s_cbranch_vccz L_polldone_14
    s_sub_u32 s58, s58, 1
    s_cbranch_scc0 L_poll_13
L_polldone_14:
    s_mov_b64 exec, -1
L_nopoll_12:
    s_waitcnt lgkmcnt(0)
    s_barrier
    s_add_u32 m0, s56, 0
    s_nop 0
    buffer_load_dwordx4 v250, s[12:15], s44 offen offset:0 sc1 lds
    v_and_b32 v35, 0xffff, v35
    v_and_b32 v39, 0xffff, v39
    v_and_b32 v43, 0xffff, v43
    v_and_b32 v47, 0xffff, v47
    buffer_load_dwordx4 v250, s[12:15], s44 offen offset:1024 sc1 lds
    v_and_b32 v51, 0xffff, v51
    v_and_b32 v55, 0xffff, v55
    v_and_b32 v59, 0xffff, v59
    v_and_b32 v63, 0xffff, v63
    buffer_load_dwordx4 v250, s[12:15], s44 offen offset:2048 sc1 lds
    v_and_b32 v67, 0xffff, v67
    v_and_b32 v71, 0xffff, v71
    v_and_b32 v75, 0xffff, v75
    v_and_b32 v79, 0xffff, v79
    buffer_load_dwordx4 v250, s[12:15], s44 offen offset:3072 sc1 lds
    v_and_b32 v83, 0xffff, v83
    v_and_b32 v87, 0xffff, v87
    v_and_b32 v91, 0xffff, v91
    v_and_b32 v95, 0xffff, v95
    s_add_u32 m0, s56, 16384
    s_nop 0
    buffer_load_dwordx4 v250, s[12:15], s45 offen offset:0 sc1 lds
    v_and_b32 v99, 0xffff, v99
    v_and_b32 v103, 0xffff, v103
    v_and_b32 v107, 0xffff, v107
    v_and_b32 v111, 0xffff, v111
    buffer_load_dwordx4 v250, s[12:15], s45 offen offset:1024 sc1 lds
    v_and_b32 v115, 0xffff, v115
    v_and_b32 v119, 0xffff, v119
    v_and_b32 v123, 0xffff, v123
    v_and_b32 v127, 0xffff, v127
    buffer_load_dwordx4 v250, s[12:15], s45 offen offset:2048 sc1 lds
    v_and_b32 v131, 0xffff, v131
    v_and_b32 v135, 0xffff, v135
    v_and_b32 v139, 0xffff, v139
    v_and_b32 v143, 0xffff, v143
    buffer_load_dwordx4 v250, s[12:15], s45 offen offset:3072 sc1 lds
    v_and_b32 v147, 0xffff, v147
    v_and_b32 v151, 0xffff, v151
    v_and_b32 v155, 0xffff, v155
    v_and_b32 v159, 0xffff, v159
    s_add_u32 m0, s56, 32768
    s_nop 0
    buffer_load_dwordx4 v250, s[12:15], s46 offen offset:0 sc1 lds
    buffer_load_dwordx4 v250, s[12:15], s46 offen offset:1024 sc1 lds
    buffer_load_dwordx4 v250, s[12:15], s46 offen offset:2048 sc1 lds
    buffer_load_dwordx4 v250, s[12:15], s46 offen offset:3072 sc1 lds
    s_add_u32 m0, s56, 49152
    s_nop 0
    buffer_load_dwordx4 v250, s[12:15], s47 offen offset:0 sc1 lds
    buffer_load_dwordx4 v250, s[12:15], s47 offen offset:1024 sc1 lds
    buffer_load_dwordx4 v250, s[12:15], s47 offen offset:2048 sc1 lds
    buffer_load_dwordx4 v250, s[12:15], s47 offen offset:3072 sc1 lds
    s_waitcnt vmcnt(12)
    s_barrier
    ds_read_b128 v[160:163], v4 offset:0
    ds_read_b128 v[164:167], v4 offset:1024
    ds_read_b128 v[168:171], v4 offset:2048
    ds_read_b128 v[172:175], v4 offset:3072
    ds_read_b128 v[176:179], v4 offset:4096
    ds_read_b128 v[180:183], v4 offset:5120
    ds_read_b128 v[184:187], v4 offset:6144
    ds_read_b128 v[188:191], v4 offset:7168
    s_waitcnt lgkmcnt(4)
    v_xor_b32 v5, s53, v163
    v_bitop3_b32 v5, v5, v167, s53 bitop3:0xf6
    v_bitop3_b32 v5, v5, v171, s53 bitop3:0xf6
    v_bitop3_b32 v5, v5, v175, s53 bitop3:0xf6
    v_cmp_lt_u32 vcc, 0xffff, v5
    s_nop 1
    s_cbranch_vccnz L_stale0
L_fresh0:
    v_mfma_f32_32x32x16_bf16 v[224:239], v[32:35], v[160:163], 0
    v_mfma_f32_32x32x16_bf16 v[224:239], v[36:39], v[164:167], v[224:239]
    s_waitcnt lgkmcnt(0)
    v_xor_b32 v5, s53, v179
    v_bitop3_b32 v5, v5, v183, s53 bitop3:0xf6
    v_bitop3_b32 v5, v5, v187, s53 bitop3:0xf6
    v_bitop3_b32 v5, v5, v191, s53 bitop3:0xf6
    v_cmp_lt_u32 vcc, 0xffff, v5
    v_mfma_f32_32x32x16_bf16 v[224:239], v[40:43], v[168:171], v[224:239]
    v_mfma_f32_32x32x16_bf16 v[224:239], v[44:47], v[172:175], v[224:239]
    s_cbranch_vccnz L_stale1
L_fresh1:
    v_mfma_f32_32x32x16_bf16 v[224:239], v[48:51], v[176:179], v[224:239]
    s_waitcnt vmcnt(8)
    s_barrier
    ds_read_b128 v[192:195], v4 offset:16384
    ds_read_b128 v[196:199], v4 offset:17408
    ds_read_b128 v[200:203], v4 offset:18432
    ds_read_b128 v[204:207], v4 offset:19456
    v_mfma_f32_32x32x16_bf16 v[224:239], v[52:55], v[180:183], v[224:239]
    ds_read_b128 v[208:211], v4 offset:20480
    ds_read_b128 v[212:215], v4 offset:21504
    ds_read_b128 v[216:219], v4 offset:22528
    ds_read_b128 v[220:223], v4 offset:23552
    v_mfma_f32_32x32x16_bf16 v[224:239], v[56:59], v[184:187], v[224:239]
    s_waitcnt lgkmcnt(4)
    v_xor_b32 v5, s53, v195
    v_bitop3_b32 v5, v5, v199, s53 bitop3:0xf6
    v_bitop3_b32 v5, v5, v203, s53 bitop3:0xf6
    v_bitop3_b32 v5, v5, v207, s53 bitop3:0xf6
    v_cmp_lt_u32 vcc, 0xffff, v5
    v_mfma_f32_32x32x16_bf16 v[224:239], v[60:63], v[188:191], v[224:239]
    s_nop 0
    s_cbranch_vccnz L_stale2
L_fresh2:
    v_mfma_f32_32x32x16_bf16 v[224:239], v[64:67], v[192:195], v[224:239]
    v_mfma_f32_32x32x16_bf16 v[224:239], v[68:71], v[196:199], v[224:239]
    s_waitcnt lgkmcnt(0)
    v_xor_b32 v5, s53, v211
    v_bitop3_b32 v5, v5, v215, s53 bitop3:0xf6
    v_bitop3_b32 v5, v5, v219, s53 bitop3:0xf6
    v_bitop3_b32 v5, v5, v223, s53 bitop3:0xf6
    v_cmp_lt_u32 vcc, 0xffff, v5
    v_mfma_f32_32x32x16_bf16 v[224:239], v[72:75], v[200:203], v[224:239]
    v_mfma_f32_32x32x16_bf16 v[224:239], v[76:79], v[204:207], v[224:239]
    s_cbranch_vccnz L_stale3
L_fresh3:
    v_mfma_f32_32x32x16_bf16 v[224:239], v[80:83], v[208:211], v[224:239]
    s_waitcnt vmcnt(4)
    s_barrier
    ds_read_b128 v[160:163], v4 offset:32768
    ds_read_b128 v[164:167], v4 offset:33792
    ds_read_b128 v[168:171], v4 offset:34816
    ds_read_b128 v[172:175], v4 offset:35840
    v_mfma_f32_32x32x16_bf16 v[224:239], v[84:87], v[212:215], v[224:239]
    ds_read_b128 v[176:179], v4 offset:36864
    ds_read_b128 v[180:183], v4 offset:37888
    ds_read_b128 v[184:187], v4 offset:38912
    ds_read_b128 v[188:191], v4 offset:39936
    v_mfma_f32_32x32x16_bf16 v[224:239], v[88:91], v[216:219], v[224:239]
    s_waitcnt lgkmcnt(4)
    v_xor_b32 v5, s53, v163
    v_bitop3_b32 v5, v5, v167, s53 bitop3:0xf6
    v_bitop3_b32 v5, v5, v171, s53 bitop3:0xf6
    v_bitop3_b32 v5, v5, v175, s53 bitop3:0xf6
    v_cmp_lt_u32 vcc, 0xffff, v5
    v_mfma_f32_32x32x16_bf16 v[224:239], v[92:95], v[220:223], v[224:239]
    s_nop 0
    s_cbranch_vccnz L_stale4
L_fresh4:
    v_mfma_f32_32x32x16_bf16 v[224:239], v[96:99], v[160:163], v[224:239]
    v_mfma_f32_32x32x16_bf16 v[224:239], v[100:103], v[164:167], v[224:239]
    s_waitcnt lgkmcnt(0)
    v_xor_b32 v5, s53, v179
    v_bitop3_b32 v5, v5, v183, s53 bitop3:0xf6
    v_bitop3_b32 v5, v5, v187, s53 bitop3:0xf6
    v_bitop3_b32 v5, v5, v191, s53 bitop3:0xf6
    v_cmp_lt_u32 vcc, 0xffff, v5
    v_mfma_f32_32x32x16_bf16 v[224:239], v[104:107], v[168:171], v[224:239]
    v_mfma_f32_32x32x16_bf16 v[224:239], v[108:111], v[172:175], v[224:239]
    s_cbranch_vccnz L_stale5
L_fresh5:
    v_mfma_f32_32x32x16_bf16 v[224:239], v[112:115], v[176:179], v[224:239]
    s_waitcnt vmcnt(0)
    s_barrier
    ds_read_b128 v[192:195], v4 offset:49152
    ds_read_b128 v[196:199], v4 offset:50176
    ds_read_b128 v[200:203], v4 offset:51200
    ds_read_b128 v[204:207], v4 offset:52224
    v_mfma_f32_32x32x16_bf16 v[224:239], v[116:119], v[180:183], v[224:239]
    ds_read_b128 v[208:211], v4 offset:53248
    ds_read_b128 v[212:215], v4 offset:54272
    ds_read_b128 v[216:219], v4 offset:55296
    ds_read_b128 v[220:223], v4 offset:56320
    v_mfma_f32_32x32x16_bf16 v[224:239], v[120:123], v[184:187], v[224:239]
    s_waitcnt lgkmcnt(4)
    v_xor_b32 v5, s53, v195
    v_bitop3_b32 v5, v5, v199, s53 bitop3:0xf6
    v_bitop3_b32 v5, v5, v203, s53 bitop3:0xf6
    v_bitop3_b32 v5, v5, v207, s53 bitop3:0xf6
    v_cmp_lt_u32 vcc, 0xffff, v5
    v_mfma_f32_32x32x16_bf16 v[224:239], v[124:127], v[188:191], v[224:239]
    s_nop 0
    s_cbranch_vccnz L_stale6
L_fresh6:
    v_mfma_f32_32x32x16_bf16 v[224:239], v[128:131], v[192:195], v[224:239]
    v_mfma_f32_32x32x16_bf16 v[224:239], v[132:135], v[196:199], v[224:239]
    s_waitcnt lgkmcnt(0)
    v_xor_b32 v5, s53, v211
    v_bitop3_b32 v5, v5, v215, s53 bitop3:0xf6
    v_bitop3_b32 v5, v5, v219, s53 bitop3:0xf6
    v_bitop3_b32 v5, v5, v223, s53 bitop3:0xf6
    v_cmp_lt_u32 vcc, 0xffff, v5
    v_mfma_f32_32x32x16_bf16 v[224:239], v[136:139], v[200:203], v[224:239]
    v_mfma_f32_32x32x16_bf16 v[224:239], v[140:143], v[204:207], v[224:239]
    s_cbranch_vccnz L_stale7
L_fresh7:
    v_mfma_f32_32x32x16_bf16 v[224:239], v[144:147], v[208:211], v[224:239]
    v_mfma_f32_32x32x16_bf16 v[224:239], v[148:151], v[212:215], v[224:239]
    v_mfma_f32_32x32x16_bf16 v[224:239], v[152:155], v[216:219], v[224:239]
    v_mfma_f32_32x32x16_bf16 v[224:239], v[156:159], v[220:223], v[224:239]
    s_nop 11
    v_cvt_pk_bf16_f32 v240, v224, v225
    v_cvt_pk_bf16_f32 v241, v226, v227
    v_cvt_pk_bf16_f32 v242, v228, v229
    v_cvt_pk_bf16_f32 v243, v230, v231
    ds_write_b128 v8, v[240:243]
    v_cvt_pk_bf16_f32 v244, v232, v233
    v_cvt_pk_bf16_f32 v245, v234, v235
    v_cvt_pk_bf16_f32 v246, v236, v237
    v_cvt_pk_bf16_f32 v247, v238, v239
    ds_write_b128 v8, v[244:247] offset:16
    ds_read_b128 v[248:251], v9
    ds_read_b128 v[252:255], v9 offset:1280
    s_waitcnt lgkmcnt(1)
    buffer_store_dwordx4 v[248:251], v10, s[36:39], s48 offen sc1
    s_waitcnt lgkmcnt(0)
    buffer_store_dwordx4 v[252:255], v10, s[36:39], s51 offen sc1
    s_endpgm
L_stale0:
    s_mov_b32 s58, 40000
    s_add_u32 s62, s50, 0
L_again0:
    buffer_load_dwordx4 v[160:163], v250, s[12:15], s62 offen offset:0 sc1
    buffer_load_dwordx4 v[164:167], v250, s[12:15], s62 offen offset:1024 sc1
    buffer_load_dwordx4 v[168:171], v250, s[12:15], s62 offen offset:2048 sc1
    buffer_load_dwordx4 v[172:175], v250, s[12:15], s62 offen offset:3072 sc1
    s_waitcnt vmcnt(0)
    v_xor_b32 v5, s53, v163
    v_bitop3_b32 v5, v5, v167, s53 bitop3:0xf6
    v_bitop3_b32 v5, v5, v171, s53 bitop3:0xf6
    v_bitop3_b32 v5, v5, v175, s53 bitop3:0xf6
    v_cmp_lt_u32 vcc, 0xffff, v5
    s_sub_u32 s58, s58, 1
    s_cbranch_scc1 L_fresh0
    s_cbranch_vccnz L_again0
    s_branch L_fresh0
L_stale1:
    s_mov_b32 s58, 40000
    s_add_u32 s62, s50, 4096
L_again1:
    buffer_load_dwordx4 v[176:179], v250, s[12:15], s62 offen offset:0 sc1
    buffer_load_dwordx4 v[180:183], v250, s[12:15], s62 offen offset:1024 sc1
    buffer_load_dwordx4 v[184:187], v250, s[12:15], s62 offen offset:2048 sc1
    buffer_load_dwordx4 v[188:191], v250, s[12:15], s62 offen offset:3072 sc1
    s_waitcnt vmcnt(0)
    v_xor_b32 v5, s53, v179
    v_bitop3_b32 v5, v5, v183, s53 bitop3:0xf6
    v_bitop3_b32 v5, v5, v187, s53 bitop3:0xf6
    v_bitop3_b32 v5, v5, v191, s53 bitop3:0xf6
    v_cmp_lt_u32 vcc, 0xffff, v5
    s_sub_u32 s58, s58, 1
    s_cbranch_scc1 L_fresh1
    s_cbranch_vccnz L_again1
    s_branch L_fresh1
L_stale2:
    s_mov_b32 s58, 40000
    s_add_u32 s62, s50, 8192
L_again2:
    buffer_load_dwordx4 v[192:195], v250, s[12:15], s62 offen offset:0 sc1
    buffer_load_dwordx4 v[196:199], v250, s[12:15], s62 offen offset:1024 sc1
    buffer_load_dwordx4 v[200:203], v250, s[12:15], s62 offen offset:2048 sc1
    buffer_load_dwordx4 v[204:207], v250, s[12:15], s62 offen offset:3072 sc1
    s_waitcnt vmcnt(0)
    v_xor_b32 v5, s53, v195
    v_bitop3_b32 v5, v5, v199, s53 bitop3:0xf6
    v_bitop3_b32 v5, v5, v203, s53 bitop3:0xf6
    v_bitop3_b32 v5, v5, v207, s53 bitop3:0xf6
    v_cmp_lt_u32 vcc, 0xffff, v5
    s_sub_u32 s58, s58, 1
    s_cbranch_scc1 L_fresh2
    s_cbranch_vccnz L_again2
    s_branch L_fresh2
L_stale3:
    s_mov_b32 s58, 40000
    s_add_u32 s62, s50, 12288
L_again3:
    buffer_load_dwordx4 v[208:211], v250, s[12:15], s62 offen offset:0 sc1
    buffer_load_dwordx4 v[212:215], v250, s[12:15], s62 offen offset:1024 sc1
    buffer_load_dwordx4 v[216:219], v250, s[12:15], s62 offen offset:2048 sc1
    buffer_load_dwordx4 v[220:223], v250, s[12:15], s62 offen offset:3072 sc1
    s_waitcnt vmcnt(0)
    v_xor_b32 v5, s53, v211
    v_bitop3_b32 v5, v5, v215, s53 bitop3:0xf6
    v_bitop3_b32 v5, v5, v219, s53 bitop3:0xf6
    v_bitop3_b32 v5, v5, v223, s53 bitop3:0xf6
    v_cmp_lt_u32 vcc, 0xffff, v5
    s_sub_u32 s58, s58, 1
    s_cbranch_scc1 L_fresh3
    s_cbranch_vccnz L_again3
    s_branch L_fresh3
L_stale4:
    s_mov_b32 s58, 40000
    s_add_u32 s62, s50, 16384
L_again4:
    buffer_load_dwordx4 v[160:163], v250, s[12:15], s62 offen offset:0 sc1
    buffer_load_dwordx4 v[164:167], v250, s[12:15], s62 offen offset:1024 sc1
    buffer_load_dwordx4 v[168:171], v250, s[12:15], s62 offen offset:2048 sc1
    buffer_load_dwordx4 v[172:175], v250, s[12:15], s62 offen offset:3072 sc1
    s_waitcnt vmcnt(0)
    v_xor_b32 v5, s53, v163
    v_bitop3_b32 v5, v5, v167, s53 bitop3:0xf6
    v_bitop3_b32 v5, v5, v171, s53 bitop3:0xf6
    v_bitop3_b32 v5, v5, v175, s53 bitop3:0xf6
    v_cmp_lt_u32 vcc, 0xffff, v5
    s_sub_u32 s58, s58, 1
    s_cbranch_scc1 L_fresh4
    s_cbranch_vccnz L_again4
    s_branch L_fresh4
L_stale5:
    s_mov_b32 s58, 40000
    s_add_u32 s62, s50, 20480
L_again5:
    buffer_load_dwordx4 v[176:179], v250, s[12:15], s62 offen offset:0 sc1
    buffer_load_dwordx4 v[180:183], v250, s[12:15], s62 offen offset:1024 sc1
    buffer_load_dwordx4 v[184:187], v250, s[12:15], s62 offen offset:2048 sc1
    buffer_load_dwordx4 v[188:191], v250, s[12:15], s62 offen offset:3072 sc1
    s_waitcnt vmcnt(0)
    v_xor_b32 v5, s53, v179
    v_bitop3_b32 v5, v5, v183, s53 bitop3:0xf6
    v_bitop3_b32 v5, v5, v187, s53 bitop3:0xf6
    v_bitop3_b32 v5, v5, v191, s53 bitop3:0xf6
    v_cmp_lt_u32 vcc, 0xffff, v5
    s_sub_u32 s58, s58, 1
    s_cbranch_scc1 L_fresh5
    s_cbranch_vccnz L_again5
    s_branch L_fresh5
L_stale6:
    s_mov_b32 s58, 40000
    s_add_u32 s62, s50, 24576
L_again6:
    buffer_load_dwordx4 v[192:195], v250, s[12:15], s62 offen offset:0 sc1
    buffer_load_dwordx4 v[196:199], v250, s[12:15], s62 offen offset:1024 sc1
    buffer_load_dwordx4 v[200:203], v250, s[12:15], s62 offen offset:2048 sc1
    buffer_load_dwordx4 v[204:207], v250, s[12:15], s62 offen offset:3072 sc1
    s_waitcnt vmcnt(0)
    v_xor_b32 v5, s53, v195
    v_bitop3_b32 v5, v5, v199, s53 bitop3:0xf6
    v_bitop3_b32 v5, v5, v203, s53 bitop3:0xf6
    v_bitop3_b32 v5, v5, v207, s53 bitop3:0xf6
    v_cmp_lt_u32 vcc, 0xffff, v5
    s_sub_u32 s58, s58, 1
    s_cbranch_scc1 L_fresh6
    s_cbranch_vccnz L_again6
    s_branch L_fresh6
L_stale7:
    s_mov_b32 s58, 40000
    s_add_u32 s62, s50, 28672
L_again7:
    buffer_load_dwordx4 v[208:211], v250, s[12:15], s62 offen offset:0 sc1
    buffer_load_dwordx4 v[212:215], v250, s[12:15], s62 offen offset:1024 sc1
    buffer_load_dwordx4 v[216:219], v250, s[12:15], s62 offen offset:2048 sc1
    buffer_load_dwordx4 v[220:223], v250, s[12:15], s62 offen offset:3072 sc1
    s_waitcnt vmcnt(0)
    v_xor_b32 v5, s53, v211
    v_bitop3_b32 v5, v5, v215, s53 bitop3:0xf6
    v_bitop3_b32 v5, v5, v219, s53 bitop3:0xf6
    v_bitop3_b32 v5, v5, v223, s53 bitop3:0xf6
    v_cmp_lt_u32 vcc, 0xffff, v5
    s_sub_u32 s58, s58, 1
    s_cbranch_scc1 L_fresh7
    s_cbranch_vccnz L_again7
    s_branch L_fresh7
L_nojob:
    s_cmp_lg_u32 s2, 511
    s_cbranch_scc1 L_nojob_end
    v_min_u32 v6, 223, v0
    v_lshlrev_b32 v6, 7, v6
    v_add_u32 v6, 69632, v6
    s_mov_b32 s58, 40000
    s_mov_b64 exec, -1
L_poll_15:
    buffer_load_dword v7, v6, s[12:15], 0 offen sc1
L_pollchk_17:
    s_waitcnt vmcnt(0)
    v_cmp_ne_u32 vcc, s41, v7
    s_sub_u32 s58, s58, 1
    s_nop 0
    s_cbranch_vccz L_polldone_16
    s_cbranch_scc1 L_polldone_16
    s_sleep 16
    s_branch L_poll_15
L_polldone_16:
    s_mov_b64 exec, -1
    v_lshlrev_b32 v6, 7, v0
    v_add_u32 v6, 4096, v6
    s_mov_b32 s58, 40000
    s_mov_b64 exec, -1
L_poll_18:
    buffer_load_dword v7, v6, s[12:15], 0 offen sc1
L_pollchk_20:
    s_waitcnt vmcnt(0)
    v_cmp_ne_u32 vcc, s41, v7
    s_sub_u32 s58, s58, 1
    s_nop 0
    s_cbranch_vccz L_polldone_19
    s_cbranch_scc1 L_polldone_19
    s_sleep 16
    s_branch L_poll_18
L_polldone_19:
    s_mov_b64 exec, -1
    s_barrier
    s_mov_b32 s4, s28
    s_mov_b32 s5, s29
    s_mov_b32 s6, 256
    s_mov_b32 s7, 0x00020000
    s_mov_b32 s61, 0
    s_cmp_lg_u32 s16, 0
    s_cbranch_scc1 L_noflag_21
    v_lshlrev_b32 v19, 2, v1
    v_mov_b32 v20, s41
    s_mov_b32 exec_hi, 0
    buffer_store_dword v20, v19, s[4:7], s61 offen sc1
    s_mov_b64 exec, -1
L_noflag_21:
L_nojob_end:
    s_endpgm
L_notyet:
    ds_read_b64_tr_b16 v[136:137], v15 offset:32768
    ds_read_b64_tr_b16 v[138:139], v15 offset:33024
    ds_read_b64_tr_b16 v[140:141], v15 offset:36864
    ds_read_b64_tr_b16 v[142:143], v15 offset:37120
    ds_read_b64_tr_b16 v[144:145], v15 offset:40960
    ds_read_b64_tr_b16 v[146:147], v15 offset:41216
    ds_read_b64_tr_b16 v[148:149], v15 offset:45056
    ds_read_b64_tr_b16 v[150:151], v15 offset:45312
    s_waitcnt lgkmcnt(6)
    v_mfma_f32_32x32x16_bf16 v[216:231], v[136:139], v[88:91], v[216:231]
    ds_read_b64_tr_b16 v[152:153], v15 offset:33792
    ds_read_b64_tr_b16 v[154:155], v15 offset:34048
    s_waitcnt lgkmcnt(6)
    v_mfma_f32_32x32x16_bf16 v[216:231], v[140:143], v[92:95], v[216:231]
    ds_read_b64_tr_b16 v[156:157], v15 offset:37888
    ds_read_b64_tr_b16 v[158:159], v15 offset:38144
    s_waitcnt lgkmcnt(6)
    v_mfma_f32_32x32x16_bf16 v[216:231], v[144:147], v[96:99], v[216:231]
    ds_read_b64_tr_b16 v[160:161], v15 offset:41984
    ds_read_b64_tr_b16 v[162:163], v15 offset:42240
    s_waitcnt lgkmcnt(6)
    v_mfma_f32_32x32x16_bf16 v[216:231], v[148:151], v[100:103], v[216:231]
    ds_read_b64_tr_b16 v[164:165], v15 offset:46080
    ds_read_b64_tr_b16 v[166:167], v15 offset:46336
    s_waitcnt lgkmcnt(6)
    v_mfma_f32_32x32x16_bf16 v[216:231], v[152:155], v[104:107], v[216:231]
    ds_read_b64_tr_b16 v[136:137], v15 offset:34816
    ds_read_b64_tr_b16 v[138:139], v15 offset:35072
    s_waitcnt lgkmcnt(6)
    v_mfma_f32_32x32x16_bf16 v[216:231], v[156:159], v[108:111], v[216:231]
    ds_read_b64_tr_b16 v[140:141], v15 offset:38912
    ds_read_b64_tr_b16 v[142:143], v15 offset:39168
    s_waitcnt lgkmcnt(6)
    v_mfma_f32_32x32x16_bf16 v[216:231], v[160:163], v[112:115], v[216:231]
    ds_read_b64_tr_b16 v[144:145], v15 offset:43008
    ds_read_b64_tr_b16 v[146:147], v15 offset:43264
    s_waitcnt lgkmcnt(6)
    v_mfma_f32_32x32x16_bf16 v[216:231], v[164:167], v[116:119], v[216:231]
    ds_read_b64_tr_b16 v[148:149], v15 offset:47104
    ds_read_b64_tr_b16 v[150:151], v15 offset:47360
    s_waitcnt lgkmcnt(6)
    v_mfma_f32_32x32x16_bf16 v[216:231], v[136:139], v[120:123], v[216:231]
    s_waitcnt lgkmcnt(4)
    v_mfma_f32_32x32x16_bf16 v[216:231], v[140:143], v[124:127], v[216:231]
    s_waitcnt lgkmcnt(2)
    v_mfma_f32_32x32x16_bf16 v[216:231], v[144:147], v[128:131], v[216:231]
    s_waitcnt lgkmcnt(0)
    v_mfma_f32_32x32x16_bf16 v[216:231], v[148:151], v[132:135], v[216:231]
    s_mov_b32 s58, 40000
    s_mov_b64 exec, 15
L_poll_22:
    buffer_load_dword v7, v207, s[12:15], 0 offen sc1
L_pollchk_24:
    s_waitcnt vmcnt(0)
    v_cmp_ne_u32 vcc, s41, v7
    s_sub_u32 s58, s58, 1
    s_nop 0
    s_cbranch_vccz L_polldone_23
    s_cbranch_scc1 L_polldone_23
    s_sleep 4
    s_branch L_poll_22
L_polldone_23:
    s_mov_b64 exec, -1
    buffer_load_dwordx4 v[168:171], v19, s[20:23], 0 offen sc1
    buffer_load_dwordx4 v[172:175], v19, s[20:23], 0 offen offset:1024 sc1
    buffer_load_dwordx4 v[176:179], v20, s[12:15], 0 offen sc1
    buffer_load_dwordx4 v[180:183], v20, s[24:27], 0 offen sc1
    s_add_u32 s20, s20, 90240
    s_addc_u32 s21, s21, 0
    v_add_u32 v20, v22, v20
    buffer_load_dwordx4 v[184:187], v19, s[20:23], 0 offen sc1
    buffer_load_dwordx4 v[188:191], v19, s[20:23], 0 offen offset:1024 sc1
    buffer_load_dwordx4 v[192:195], v20, s[12:15], 0 offen sc1
    buffer_load_dwordx4 v[196:199], v20, s[24:27], 0 offen sc1
    s_add_u32 s20, s20, s45
    s_addc_u32 s21, s21, 0
    v_mad_i32_i24 v20, v22, s43, v20
    s_branch L_qepi
L_lazy:
    s_cmp_eq_u32 s19, 0
    s_cbranch_scc1 L_lazy2
    s_add_u32 s61, s60, 8192
    v_mov_b32 v8, s61
    s_mov_b32 s58, 40000
    s_mov_b64 exec, 1
L_poll_25:
    v_mov_b32 v7, 0
    buffer_atomic_or v7, v8, s[12:15], 0 offen sc0
L_pollchk_27:
    s_waitcnt vmcnt(0)
    v_cmp_ne_u32 vcc, s41, v7
    s_sub_u32 s58, s58, 1
    s_nop 0
    s_cbranch_vccz L_polldone_26
    s_cbranch_scc1 L_polldone_26
    s_sleep 8
    s_branch L_poll_25
L_polldone_26:
    s_mov_b64 exec, -1
L_lazy2:
    s_mov_b32 s58, 40000
    s_mov_b64 exec, 0xffff
L_poll_28:
    buffer_load_dword v7, v249, s[12:15], 0 offen sc1
L_pollchk_30:
    s_waitcnt vmcnt(0)
    v_cmp_ne_u32 vcc, s41, v7
    s_sub_u32 s58, s58, 1
    s_nop 0
    s_cbranch_vccz L_polldone_29
    s_cbranch_scc1 L_polldone_29
    s_sleep 4
    s_branch L_poll_28
L_polldone_29:
    s_mov_b64 exec, -1
    s_branch L_lazyback
L_lazy3:
    s_mov_b32 s58, 40000
    s_mov_b64 exec, -1
L_poll_31:
    buffer_load_dword v7, v248, s[12:15], 0 offen sc1
L_pollchk_33:
    s_waitcnt vmcnt(0)
    v_cmp_ne_u32 vcc, s41, v7
    s_sub_u32 s58, s58, 1
    s_nop 0
    s_cbranch_vccz L_polldone_32
    s_cbranch_scc1 L_polldone_32
    s_sleep 4
    s_branch L_poll_31
L_polldone_32:
    s_mov_b64 exec, -1
    s_branch L_lazyback3
L_slow:
    v_mov_b32 v8, 0xff800000
    s_mov_b32 s59, 589824
    s_mov_b32 s58, 64
L_slow1:
    buffer_load_dwordx4 v[168:171], v19, s[12:15], s59 offen sc1
    buffer_load_dwordx4 v[172:175], v19, s[12:15], s59 offen offset:1024 sc1
    s_add_u32 s59, s59, 90240
    s_waitcnt vmcnt(0)
    v_mfma_f32_32x32x16_bf16 v[120:135], v[168:171], v[112:115], 0
    v_mfma_f32_32x32x16_bf16 v[120:135], v[172:175], v[116:119], v[120:135]
    s_nop 11
    v_max3_f32 v8, v8, v120, v121
    v_max3_f32 v8, v8, v122, v123
    v_max3_f32 v8, v8, v124, v125
    v_max3_f32 v8, v8, v126, v127
    v_max3_f32 v8, v8, v128, v129
    v_max3_f32 v8, v8, v130, v131
    v_max3_f32 v8, v8, v132, v133
    v_max3_f32 v8, v8, v134, v135
    s_sub_u32 s58, s58, 1
    s_cmp_lg_u32 s58, 0
    s_cbranch_scc1 L_slow1
    v_mov_b32 v7, v8
    s_nop 1
    v_permlane32_swap_b32 v8, v7
    s_nop 1
    v_max_f32 v8, v8, v7
    v_mov_b32 v72, 0
    v_mov_b32 v73, 0
    v_mov_b32 v74, 0
    v_mov_b32 v75, 0
    v_mov_b32 v76, 0
    v_mov_b32 v77, 0
    v_mov_b32 v78, 0
    v_mov_b32 v79, 0
    v_mov_b32 v80, 0
    v_mov_b32 v81, 0
    v_mov_b32 v82, 0
    v_mov_b32 v83, 0
    v_mov_b32 v84, 0
    v_mov_b32 v85, 0
    v_mov_b32 v86, 0
    v_mov_b32 v87, 0
    s_mov_b32 s59, 589824
    s_mov_b32 s58, 64
L_slow2:
    buffer_load_dwordx4 v[168:171], v19, s[12:15], s59 offen sc1
    buffer_load_dwordx4 v[172:175], v19, s[12:15], s59 offen offset:1024 sc1
    s_add_u32 s59, s59, 90240
    buffer_load_dwordx4 v[176:179], v251, s[12:15], 0 offen sc1
    buffer_load_dwordx4 v[180:183], v251, s[24:27], 0 offen sc1
    v_add_u32 v251, v22, v251
    s_waitcnt vmcnt(0)
    v_mfma_f32_32x32x16_bf16 v[120:135], v[168:171], v[112:115], 0
    v_mfma_f32_32x32x16_bf16 v[120:135], v[172:175], v[116:119], v[120:135]
    s_nop 11
    v_sub_f32 v120, v120, v8
    v_sub_f32 v121, v121, v8
    v_sub_f32 v122, v122, v8
    v_sub_f32 v123, v123, v8
    v_sub_f32 v124, v124, v8
    v_sub_f32 v125, v125, v8
    v_sub_f32 v126, v126, v8
    v_sub_f32 v127, v127, v8
    v_sub_f32 v128, v128, v8
    v_sub_f32 v129, v129, v8
    v_sub_f32 v130, v130, v8
    v_sub_f32 v131, v131, v8
    v_sub_f32 v132, v132, v8
    v_sub_f32 v133, v133, v8
    v_sub_f32 v134, v134, v8
    v_sub_f32 v135, v135, v8
    v_exp_f32 v120, v120
    v_exp_f32 v121, v121
    v_exp_f32 v122, v122
    v_exp_f32 v123, v123
    v_exp_f32 v124, v124
    v_exp_f32 v125, v125
    v_exp_f32 v126, v126
    v_exp_f32 v127, v127
    v_exp_f32 v128, v128
    v_exp_f32 v129, v129
    v_exp_f32 v130, v130
    v_exp_f32 v131, v131
    v_exp_f32 v132, v132
    v_exp_f32 v133, v133
    v_exp_f32 v134, v134
    v_exp_f32 v135, v135
    v_smfmac_f32_32x32x32_bf16 v[72:87], v[176:179], v[120:127], v5
    s_nop 0
    v_smfmac_f32_32x32x32_bf16 v[72:87], v[180:183], v[128:135], v5
    s_nop 15
    s_sub_u32 s58, s58, 1
    s_cmp_lg_u32 s58, 0
    s_cbranch_scc1 L_slow2
    v_rcp_f32 v20, v79
    s_nop 0
    v_pk_mul_f32 v[72:73], v[72:73], v[20:21] op_sel_hi:[1,0]
    v_pk_mul_f32 v[74:75], v[74:75], v[20:21] op_sel_hi:[1,0]
    v_pk_mul_f32 v[76:77], v[76:77], v[20:21] op_sel_hi:[1,0]
    v_pk_mul_f32 v[78:79], v[78:79], v[20:21] op_sel_hi:[1,0]
    v_cvt_pk_bf16_f32 v24, v72, v73
    v_cvt_pk_bf16_f32 v25, v74, v75
    v_cvt_pk_bf16_f32 v26, v76, v77
    v_cvt_pk_bf16_f32 v27, v78, s53
    s_branch L_checked
L_codeend:
.section .rodata,"a"
.p2align 6
.amdhsa_kernel concat_heads__ssm_conv_s4d__softmax_full_mha__prompt_kernel
  .amdhsa_next_free_vgpr 256
  .amdhsa_next_free_sgpr 102
  .amdhsa_accum_offset 256
  .amdhsa_group_segment_fixed_size 0
  .amdhsa_kernarg_size 104
  .amdhsa_user_sgpr_count 2
  .amdhsa_user_sgpr_kernarg_segment_ptr 1
  .amdhsa_system_sgpr_workgroup_id_x 1
.end_amdhsa_kernel
```
